```python
import torch

def _softmax(x, axis=-1):
    return torch.softmax(x, dim=axis)
def _gelu(x):
    return torch.nn.functional.gelu(x, approximate="tanh")
def _silu(x):
    return torch.nn.functional.silu(x)
def _sigmoid(x):
    return torch.sigmoid(x)
def _layernorm(x, axis=-1, eps=1e-5):
    m = x.mean(dim=axis, keepdim=True)
    v = x.var(dim=axis, keepdim=True, unbiased=False)
    return (x - m) / torch.sqrt(v + eps)
def _scatter_add(tgt, idx, src, axis=0):
    return tgt.clone().index_add_(axis, idx, src)
def _segment_sum(src, seg, n):
    out = torch.zeros((n,) + src.shape[1:], dtype=src.dtype)
    return out.index_add_(0, seg, src)
def _pad(x, pw):
    flat = tuple(v for pair in reversed(pw) for v in pair)
    return torch.nn.functional.pad(x, flat)

kernel_name = 'gated_mix__softmax_full_mha__dense_activation_mish__prompt'

def setup_inputs():

    _w = (lambda a: (lambda t: t.to(torch.bfloat16) if t.is_floating_point() else t)(torch.as_tensor(a)))
    def _A_setup():
        B, S, D = 1, 2048, 448
        return {
            "x": _w((lambda *s: torch.randn(*s, dtype=torch.bfloat16) * 0.05)(B, S, D)),
            "wqkv": _w((lambda *s: torch.randn(*s, dtype=torch.bfloat16) * 0.8)(D, 3 * D)),
            "wo": _w((lambda *s: torch.randn(*s, dtype=torch.bfloat16) * 0.05)(D, D)),
        }
    _A_in = _A_setup()

    def _B_setup():
        B, S, D, F = 1, 2048, 448, 1792
        return {
            "x": _w((lambda *s: torch.randn(*s, dtype=torch.bfloat16) * 0.05)(B, S, D)),
            "w1": _w((lambda *s: torch.randn(*s, dtype=torch.bfloat16) * 12.8)(D, F) * (D ** -0.5)),
            "b1": _w((lambda *s: torch.randn(*s, dtype=torch.bfloat16) * 0.1)(F)),
            "w2": _w((lambda *s: torch.randn(*s, dtype=torch.bfloat16) * 0.1)(F, D) * (F ** -0.5)),
        }
    _B_in = _B_setup()

    return {
        "A_x": _A_in["x"],
        "A_wqkv": _A_in["wqkv"],
        "A_wo": _A_in["wo"],
        "B_x": _B_in["x"],
        "B_w1": _B_in["w1"],
        "B_b1": _B_in["b1"],
        "B_w2": _B_in["w2"],
        "gate_w": _w((lambda *s: torch.randn(*s, dtype=torch.bfloat16) * 0.05)(448) * 16.0),
    }

def reference(A_x, A_wqkv, A_wo, B_x, B_w1, B_b1, B_w2, gate_w):
    def _A_ref(x, wqkv, wo):
        B, S, D = x.shape
        H = 16; Dh = D // H
        qkv = (lambda x, *d: x.permute(*d))((x @ wqkv).reshape(B, S, 3, H, Dh), 2, 0, 3, 1, 4)
        q, k, v = qkv[0], qkv[1], qkv[2]
        scale = Dh ** -0.5
        scores = torch.einsum("bhqd,bhkd->bhqk", q, k) * scale
        p = _softmax(scores, axis=-1)
        o = torch.einsum("bhqk,bhkd->bhqd", p, v)
        return (lambda x, *d: x.permute(*d))(o, 0, 2, 1, 3).reshape(B, S, D) @ wo

    def _B_ref(x, w1, b1, w2):
        h = torch.einsum("bsd,df->bsf", x, w1) + b1
        sp = torch.log1p(torch.exp(-torch.abs(h))) + torch.where(h > 0, h, torch.zeros_like(h))
        act = h * torch.tanh(sp)
        return torch.einsum("bsf,fd->bsd", act, w2)

    x = A_x
    g = _sigmoid((x * gate_w).sum(-1, keepdims=True))
    a = _A_ref(x, A_wqkv, A_wo)
    b = _B_ref(x, B_w1, B_b1, B_w2)
    return g * a + (1 - g) * b
```

```asm
; @launch grid=(256,1,1) block=(512,1,1) lds=163840
.amdgcn_target "amdgcn-amd-amdhsa--gfx950"
.text
.globl gated_mix__softmax_full_mha__dense_activation_mish__prompt_kernel
.p2align 8
.type gated_mix__softmax_full_mha__dense_activation_mish__prompt_kernel,@function
gated_mix__softmax_full_mha__dense_activation_mish__prompt_kernel:
KST:
  s_load_dwordx16 s[4:19], s[0:1], 0
  s_load_dwordx2 s[20:21], s[0:1], 80
  s_load_dwordx2 s[22:23], s[0:1], 64
  s_cmp_ge_u32 s2, 256
  s_cbranch_scc0 EL_f5102
  s_endpgm
EL_f5102:
  v_lshrrev_b32 v3, 6, v0
  v_and_b32 v1, 63, v0
  s_getpc_b64 s[68:69]
  v_readfirstlane_b32 s52, v3
  s_nop 0
  s_cmp_eq_u32 s52, 7
  s_cbranch_scc0 EL_f5104
  s_lshr_b32 s3, s2, 3
  s_mul_i32 s3, s3, 9
  v_min_u32 v254, 8, v1
  v_add_u32 v254, s3, v254
  v_lshlrev_b32 v254, 7, v254
  v_min_u32 v254, 34820, v254
  global_load_dword v254, v254, s[68:69]
EL_f5104:
  s_and_b32 s3, s2, 4
  s_lshl_b32 s3, s3, 1
  s_bfe_u32 s53, s2, 0x30003
  s_add_u32 s53, s53, s3
  s_and_b32 s3, s2, 3
  s_lshl_b32 s3, s3, 2
  s_lshr_b32 s54, s2, 6
  s_add_u32 s54, s54, s3
  s_add_u32 s63, s53, s54
  s_mul_i32 s3, s63, 37
  s_lshr_b32 s3, s3, 8
  s_mul_i32 s3, s3, 7
  s_sub_u32 s63, s63, s3
  s_and_b32 s67, s52, 3
  s_lshl_b32 s55, s53, 2
  s_add_u32 s55, s55, s67
  s_lshl_b32 s61, s52, 11
  s_mul_i32 s59, s54, 168
  s_bitcmp1_b32 0x1248, s54
  s_cselect_b32 s57, 0, 1
  s_cselect_b32 s3, 15, 127
  s_and_b32 s58, s59, s3
  s_sub_u32 s59, s59, s58
  v_lshrrev_b32 v3, 3, v1
  s_lshl_b32 s3, s52, 4
  v_add_u32 v4, s3, v3
  v_mul_u32_u24 v240, 896, v4
  v_lshrrev_b32 v4, 4, v1
  v_and_b32 v5, 7, v1
  v_xor_b32 v241, v5, v4
  v_lshl_add_u32 v242, v241, 4, v240
  v_xor_b32 v241, 4, v241
  v_lshl_add_u32 v241, v241, 4, v240
  v_add_u32 v241, 6144, v241
  v_mov_b32 v240, v242
  s_lshl_b32 s3, s52, 3
  v_add_u32 v3, s3, v4
  v_mul_u32_u24 v242, 2688, v3
  v_lshlrev_b32 v3, 2, v4
  v_and_b32 v5, 15, v1
  v_xor_b32 v3, v3, v5
  v_lshl_add_u32 v242, v3, 4, v242
  v_add_u32 v243, 9728, v242
  v_mov_b32 v253, 0
  s_mul_i32 s70, s53, 114688
  s_sub_u32 s71, 1204224, s59
  s_waitcnt lgkmcnt(0)
  s_add_u32 s24, s4, s70
  s_addc_u32 s25, s5, 0
  s_mov_b32 s26, 114688
  s_mov_b32 s27, 0x20000
  s_add_u32 s28, s6, s59
  s_addc_u32 s29, s7, 0
  s_mov_b32 s30, s71
  s_mov_b32 s31, 0x20000
  s_add_u32 m0, s61, 0
  s_lshl_b32 s64, s63, 7
  buffer_load_dwordx4 v240, s[24:27], s64 offen lds
  buffer_load_dwordx4 v241, s[24:27], s64 offen offset:1024 lds
  s_add_u32 m0, s61, 16384
  s_mul_i32 s64, s63, 172032
  buffer_load_dwordx4 v242, s[28:31], s64 offen lds
  buffer_load_dwordx4 v243, s[28:31], s64 offen offset:1024 lds
  s_add_u32 s63, s63, 1
  s_cmp_eq_u32 s63, 7
  s_cselect_b32 s63, 0, s63
  global_load_dword v253, v253, s[20:21] sc1
  s_cmp_eq_u32 s52, 5
  s_cbranch_scc0 EL_f5106
  s_bfe_u32 s59, s2, 0x10002
  s_lshl_b32 s59, s59, 5
  s_lshr_b32 s3, s2, 3
  s_add_u32 s59, s59, s3
  s_mul_i32 s59, s59, 25088
  s_and_b32 s3, s2, 3
  s_mul_i32 s3, s3, 896
  s_add_u32 s59, s59, s3
  v_min_u32 v3, 48, v1
  v_mul_u32_u24 v4, 37, v3
  v_lshrrev_b32 v4, 8, v4
  v_mul_u32_u24 v4, 2688, v4
  v_lshl_add_u32 v3, v3, 7, v4
  v_add_u32 v3, s59, v3
  global_load_dword v254, v3, s[12:13]
EL_f5106:
  s_barrier
  s_add_u32 m0, s61, 32768
  s_lshl_b32 s64, s63, 7
  buffer_load_dwordx4 v240, s[24:27], s64 offen lds
  buffer_load_dwordx4 v241, s[24:27], s64 offen offset:1024 lds
  s_add_u32 m0, s61, 49152
  s_mul_i32 s64, s63, 172032
  buffer_load_dwordx4 v242, s[28:31], s64 offen lds
  buffer_load_dwordx4 v243, s[28:31], s64 offen offset:1024 lds
  s_add_u32 s63, s63, 1
  s_cmp_eq_u32 s63, 7
  s_cselect_b32 s63, 0, s63
  s_add_u32 s36, s20, 0
  s_addc_u32 s37, s21, 0
  s_mov_b32 s38, 22020096
  s_mov_b32 s39, 0x20000
  v_lshlrev_b32 v2, 4, v1
  v_mov_b32 v3, 155648
  v_mov_b32 v4, 0
  v_mov_b32 v5, 0
  s_lshl_b32 s73, s54, 4
  s_add_u32 s73, s73, s53
  s_lshl_b32 s10, s73, 7
  ds_write_b64 v3, v[4:5]
  ds_write_b64 v3, v[4:5] offset:8
  ds_write_b64 v3, v[4:5] offset:16
  v_and_b32 v3, 31, v1
  s_lshl_b32 s3, s67, 5
  v_add_u32 v4, s3, v3
  v_lshlrev_b32 v4, 7, v4
  v_bfe_u32 v3, v1, 1, 3
  v_lshrrev_b32 v5, 5, v1
  v_xor_b32 v3, v3, v5
  v_lshl_add_u32 v245, v3, 4, v4
  v_xor_b32 v246, 32, v245
  v_xor_b32 v247, 64, v245
  v_xor_b32 v248, 96, v245
  s_bfm_b32 s3, s54, 0
  s_and_b32 s3, s3, 0x1248
  s_bcnt1_i32_b32 s3, s3
  s_lshl_b32 s56, s54, 1
  s_sub_u32 s56, s56, s3
  s_lshl_b32 s56, s56, 1
  s_lshl_b32 s61, s67, 11
  v_bfe_u32 v4, v1, 4, 1
  v_lshlrev_b32 v4, 2, v4
  v_and_b32 v3, 7, v1
  v_xor_b32 v4, v4, v3
  v_lshrrev_b32 v3, 3, v1
  s_lshl_b32 s3, s67, 4
  v_add_u32 v3, s3, v3
  v_mul_u32_u24 v244, 3584, v3
  v_lshl_add_u32 v244, v4, 4, v244
  v_bfe_u32 v4, v1, 4, 1
  v_and_b32 v3, 3, v1
  v_lshl_add_u32 v4, v4, 2, v3
  v_bfe_u32 v3, v1, 2, 2
  v_lshl_add_u32 v5, v5, 3, v3
  s_cmp_lt_u32 s52, 4
  s_cbranch_scc0 EL_f5108
  s_setprio 3
  s_lshl_b32 s60, s56, 6
  s_lshl_b32 s3, s57, 7
  s_add_u32 s60, s60, s3
  s_sub_u32 s72, 1605632, s60
  s_add_u32 s63, s63, 5
  s_cmp_ge_u32 s63, 7
  s_cselect_b32 s3, 7, 0
  s_sub_u32 s63, s63, s3
  s_add_u32 s40, s12, s60
  s_addc_u32 s41, s13, 0
  s_mov_b32 s42, s72
  s_mov_b32 s43, 0x20000
  s_lshr_b32 s3, s2, 1
  s_lshl_b32 s3, s3, 2
  s_add_u32 s59, s3, s52
  s_mul_i32 s59, s59, 49
  s_lshr_b32 s59, s59, 2
  s_and_b32 s3, s2, 1
  s_mul_i32 s3, s3, 6272
  s_add_u32 s59, s59, s3
  s_lshl_b32 s3, s2, 2
  s_add_u32 s60, s3, s52
  s_mul_i32 s60, s60, 49
  s_lshr_b32 s60, s60, 4
  v_min_u32 v0, 12, v1
  v_add_u32 v0, s59, v0
  v_lshlrev_b32 v0, 7, v0
  v_min_u32 v255, 3, v1
  v_add_u32 v255, s60, v255
  v_lshlrev_b32 v255, 7, v255
  v_min_u32 v249, 6, v4
  v_lshlrev_b32 v249, 3, v249
  v_add_u32 v249, s58, v249
  v_add_u32 v250, 56, v249
  v_add_u32 v251, 112, v249
  v_lshlrev_b32 v3, 6, v3
  v_lshlrev_b32 v5, 8, v5
  v_add_u32 v5, 16384, v5
  v_xor_b32 v249, v249, v3
  v_xor_b32 v250, v250, v3
  v_xor_b32 v251, v251, v3
  v_add_u32 v249, v249, v5
  v_add_u32 v250, v250, v5
  v_add_u32 v251, v251, v5
  v_and_b32 v3, 31, v1
  v_mov_b32 v4, 0x3f803f80
  v_cmp_eq_u32 vcc, 28, v3
  s_nop 1
  v_cndmask_b32 v252, 0, v4, vcc
  s_mul_i32 s59, s54, 3
  s_cmp_lt_u32 s59, 16
  s_cselect_b32 s4, 0x3e8b97f6, 1.0
  s_mov_b32 s5, s4
  s_cmp_lt_u32 s59, 15
  s_cselect_b32 s6, 0x3e8b97f6, 1.0
  s_mov_b32 s7, s6
  s_cmp_lt_u32 s59, 14
  s_cselect_b32 s14, 0x3e8b97f6, 1.0
  s_mov_b32 s15, s14
  s_lshl_b32 s59, s59, 6
  s_add_u32 s59, s59, s55
  s_lshl_b32 s11, s59, 11
  s_add_u32 s11, s11, 1048576
  s_add_u32 s10, s10, 32768
  s_and_b32 s44, s2, 7
  s_lshl_b32 s44, s44, 1
  s_bfe_u32 s3, s2, 0x10003
  s_add_u32 s44, s44, s3
  s_lshr_b32 s45, s2, 4
  v_and_b32 v3, 0x33, v1
  v_bfe_u32 v4, v1, 2, 1
  v_bfe_u32 v5, v1, 3, 1
  v_lshl_or_b32 v3, v4, 3, v3
  v_lshl_or_b32 v3, v5, 2, v3
  v_lshlrev_b32 v6, 4, v3
  s_lshl_b32 s59, s44, 17
  s_add_u32 s59, s59, 1048576
  s_lshl_b32 s60, s52, 15
  s_add_u32 s60, s60, s59
  s_add_u32 s3, s60, 2097152
  s_add_u32 s24, s20, s3
  s_addc_u32 s25, s21, 0
  s_mov_b32 s26, 32768
  s_mov_b32 s27, 0x20000
  s_add_u32 s3, s60, 4194304
  s_add_u32 s28, s20, s3
  s_addc_u32 s29, s21, 0
  s_mov_b32 s30, 32768
  s_mov_b32 s31, 0x20000
  v_lshrrev_b32 v3, 4, v1
  v_add_u32 v3, 1, v3
  v_cmp_gt_u32 vcc, 32, v1
  s_nop 1
  v_cndmask_b32 v3, 0, v3, vcc
  v_lshl_add_u32 v3, v3, 4, s44
  v_mul_u32_u24 v3, 43, v3
  v_lshrrev_b32 v3, 7, v3
  v_and_b32 v4, 15, v1
  v_mov_b32 v5, s45
  v_cndmask_b32 v4, v5, v4, vcc
  v_lshl_add_u32 v3, v3, 4, v4
  v_lshlrev_b32 v3, 7, v3
  v_add_u32 v243, 32768, v3
  s_lshl_b32 s3, s45, 13
  s_add_u32 s59, s59, s3
  v_mov_b32 v176, 0
  v_mov_b32 v177, 0
  v_mov_b32 v178, 0
  v_mov_b32 v179, 0
  v_mov_b32 v180, 0
  v_mov_b32 v181, 0
  v_mov_b32 v182, 0
  v_mov_b32 v183, 0
  v_mov_b32 v184, 0
  v_mov_b32 v185, 0
  v_mov_b32 v186, 0
  v_mov_b32 v187, 0
  v_mov_b32 v188, 0
  v_mov_b32 v189, 0
  v_mov_b32 v190, 0
  v_mov_b32 v191, 0
  v_mov_b32 v192, 0
  v_mov_b32 v193, 0
  v_mov_b32 v194, 0
  v_mov_b32 v195, 0
  v_mov_b32 v196, 0
  v_mov_b32 v197, 0
  v_mov_b32 v198, 0
  v_mov_b32 v199, 0
  v_mov_b32 v200, 0
  v_mov_b32 v201, 0
  v_mov_b32 v202, 0
  v_mov_b32 v203, 0
  v_mov_b32 v204, 0
  v_mov_b32 v205, 0
  v_mov_b32 v206, 0
  v_mov_b32 v207, 0
  v_mov_b32 v208, 0
  v_mov_b32 v209, 0
  v_mov_b32 v210, 0
  v_mov_b32 v211, 0
  v_mov_b32 v212, 0
  v_mov_b32 v213, 0
  v_mov_b32 v214, 0
  v_mov_b32 v215, 0
  v_mov_b32 v216, 0
  v_mov_b32 v217, 0
  v_mov_b32 v218, 0
  v_mov_b32 v219, 0
  v_mov_b32 v220, 0
  v_mov_b32 v221, 0
  v_mov_b32 v222, 0
  v_mov_b32 v223, 0
  v_mov_b32 v224, 0
  v_mov_b32 v225, 0
  v_mov_b32 v226, 0
  v_mov_b32 v227, 0
  v_mov_b32 v228, 0
  v_mov_b32 v229, 0
  v_mov_b32 v230, 0
  v_mov_b32 v231, 0
  v_mov_b32 v232, 0
  v_mov_b32 v233, 0
  v_mov_b32 v234, 0
  v_mov_b32 v235, 0
  v_mov_b32 v236, 0
  v_mov_b32 v237, 0
  v_mov_b32 v238, 0
  v_mov_b32 v239, 0
  v_mov_b32 v168, 0
  v_mov_b32 v169, 0
  v_mov_b32 v170, 0
  v_mov_b32 v171, 0
  v_mov_b32 v172, 0
  v_mov_b32 v173, 0
  v_mov_b32 v174, 0
  v_mov_b32 v175, 0
  v_mov_b32 v108, 0
  v_mov_b32 v109, 0
  v_mov_b32 v110, 0
  v_mov_b32 v111, 0
  v_mov_b32 v7, 0xdddd
  v_mov_b32 v10, 155648
  s_mov_b32 s12, 4096
  s_mov_b32 s19, 6144
  s_add_u32 s3, s52, 1
  s_and_b32 s3, s3, 3
  s_mul_i32 s60, s3, 12288
  s_add_u32 s60, s60, 106496
  v_add_u32 v240, s60, v2
  s_lshl_b32 s3, s3, 11
  s_add_u32 s53, s3, s59
  s_add_u32 s3, s52, 2
  s_and_b32 s3, s3, 3
  s_mul_i32 s60, s3, 12288
  s_add_u32 s60, s60, 110592
  v_add_u32 v241, s60, v2
  s_lshl_b32 s3, s3, 11
  s_add_u32 s55, s3, s59
  s_add_u32 s3, s52, 3
  s_and_b32 s3, s3, 3
  s_mul_i32 s60, s3, 12288
  s_add_u32 s60, s60, 114688
  v_add_u32 v242, s60, v2
  s_lshl_b32 s3, s3, 11
  s_add_u32 s56, s3, s59
  s_add_u32 s3, s52, 4
  s_and_b32 s3, s3, 3
  s_mul_i32 s60, s3, 12288
  s_add_u32 s60, s60, 106496
  v_add_u32 v8, s60, v2
  s_lshl_b32 s3, s3, 11
  s_add_u32 s58, s3, s59
  s_lshl_b32 s59, s45, 2
  s_add_u32 s59, s59, s52
  s_lshl_b32 s3, s59, 4
  s_add_u32 s3, s3, s44
  s_lshl_b32 s47, s3, 11
  s_add_u32 s47, s47, 14680064
  s_lshr_b32 s51, s52, 1
  s_and_b32 s70, s2, 7
  s_lshl_b32 s70, s70, 1
  s_bfe_u32 s3, s2, 0x10003
  s_add_u32 s70, s70, s3
  s_bfe_u32 s3, s2, 0x10004
  s_lshl_b32 s70, s70, 1
  s_add_u32 s70, s70, s3
  s_lshl_b32 s70, s70, 1
  s_and_b32 s3, s52, 1
  s_add_u32 s70, s70, s3
  s_lshr_b32 s71, s2, 5
  s_lshl_b32 s3, s70, 7
  s_add_u32 s50, s3, 393216
  s_lshl_b32 s49, s70, 1
  s_add_u32 s49, s49, s51
  s_lshl_b32 s49, s49, 14
  s_add_u32 s49, s49, 14680064
  s_mul_i32 s3, s70, 28672
  s_add_u32 s32, s22, s3
  s_addc_u32 s33, s23, 0
  s_mov_b32 s34, 28672
  s_mov_b32 s35, 0x20000
  s_mov_b32 s47, s58
  s_lshl_b32 s3, s51, 9
  s_add_u32 s3, s3, s70
  s_lshl_b32 s3, s3, 11
  s_add_u32 s49, s3, 1048576
  s_cmp_lt_u32 s54, 10
  s_cbranch_scc0 EL_f5110
  s_waitcnt vmcnt(5) lgkmcnt(0)
  s_barrier
  ds_read_b128 v[16:19], v245 offset:0
  ds_read_b64_tr_b16 v[32:33], v249 offset:0
  ds_read_b64_tr_b16 v[34:35], v249 offset:1024
  ds_read_b64_tr_b16 v[48:49], v250 offset:0
  ds_read_b64_tr_b16 v[50:51], v250 offset:1024
  ds_read_b64_tr_b16 v[64:65], v251 offset:0
  ds_read_b64_tr_b16 v[66:67], v251 offset:1024
  ds_read_b128 v[20:23], v246 offset:0
  ds_read_b64_tr_b16 v[36:37], v249 offset:4096
  ds_read_b64_tr_b16 v[38:39], v249 offset:5120
  ds_read_b64_tr_b16 v[52:53], v250 offset:4096
  ds_read_b64_tr_b16 v[54:55], v250 offset:5120
  ds_read_b64_tr_b16 v[68:69], v251 offset:4096
  ds_read_b64_tr_b16 v[70:71], v251 offset:5120
  s_waitcnt lgkmcnt(11)
  v_mfma_f32_32x32x16_bf16 v[112:127], v[32:35], v[16:19], 0
  ds_read_b128 v[24:27], v247 offset:0
  ds_read_b64_tr_b16 v[40:41], v249 offset:8192
  ds_read_b64_tr_b16 v[42:43], v249 offset:9216
  s_waitcnt lgkmcnt(12)
  v_mfma_f32_32x32x16_bf16 v[128:143], v[48:51], v[16:19], 0
  ds_read_b64_tr_b16 v[56:57], v250 offset:8192
  ds_read_b64_tr_b16 v[58:59], v250 offset:9216
  s_waitcnt lgkmcnt(12)
  v_mfma_f32_32x32x16_bf16 v[144:159], v[64:67], v[16:19], 0
  ds_read_b64_tr_b16 v[72:73], v251 offset:8192
  ds_read_b64_tr_b16 v[74:75], v251 offset:9216
  s_waitcnt lgkmcnt(11)
  v_mfma_f32_32x32x16_bf16 v[112:127], v[36:39], v[20:23], v[112:127]
  ds_read_b128 v[28:31], v248 offset:0
  ds_read_b64_tr_b16 v[44:45], v249 offset:12288
  ds_read_b64_tr_b16 v[46:47], v249 offset:13312
  s_waitcnt lgkmcnt(12)
  v_mfma_f32_32x32x16_bf16 v[128:143], v[52:55], v[20:23], v[128:143]
  ds_read_b64_tr_b16 v[60:61], v250 offset:12288
  ds_read_b64_tr_b16 v[62:63], v250 offset:13312
  s_waitcnt lgkmcnt(12)
  v_mfma_f32_32x32x16_bf16 v[144:159], v[68:71], v[20:23], v[144:159]
  ds_read_b64_tr_b16 v[76:77], v251 offset:12288
  ds_read_b64_tr_b16 v[78:79], v251 offset:13312
  s_waitcnt lgkmcnt(11)
  v_mfma_f32_32x32x16_bf16 v[112:127], v[40:43], v[24:27], v[112:127]
  s_waitcnt lgkmcnt(9)
  v_mfma_f32_32x32x16_bf16 v[128:143], v[56:59], v[24:27], v[128:143]
  s_waitcnt lgkmcnt(7)
  v_mfma_f32_32x32x16_bf16 v[144:159], v[72:75], v[24:27], v[144:159]
  s_waitcnt vmcnt(0) lgkmcnt(0)
  s_barrier
  ds_read_b128 v[16:19], v245 offset:32768
  ds_read_b64_tr_b16 v[32:33], v249 offset:32768
  ds_read_b64_tr_b16 v[34:35], v249 offset:33792
  ds_read_b64_tr_b16 v[48:49], v250 offset:32768
  ds_read_b64_tr_b16 v[50:51], v250 offset:33792
  ds_read_b64_tr_b16 v[64:65], v251 offset:32768
  ds_read_b64_tr_b16 v[66:67], v251 offset:33792
  v_readfirstlane_b32 s65, v253
  s_nop 0
  s_mul_i32 s65, s65, 0x9E3779B1
  s_add_u32 s65, s65, 0x7F4A7C15
  v_mov_b32 v12, s65
  v_mov_b32 v13, s65
  v_mov_b32 v14, s65
  v_mov_b32 v15, s65
  v_mfma_f32_32x32x16_bf16 v[112:127], v[44:47], v[28:31], v[112:127]
  ds_read_b128 v[20:23], v246 offset:32768
  ds_read_b64_tr_b16 v[36:37], v249 offset:36864
  ds_read_b64_tr_b16 v[38:39], v249 offset:37888
  v_mfma_f32_32x32x16_bf16 v[128:143], v[60:63], v[28:31], v[128:143]
  ds_read_b64_tr_b16 v[52:53], v250 offset:36864
  ds_read_b64_tr_b16 v[54:55], v250 offset:37888
  v_mfma_f32_32x32x16_bf16 v[144:159], v[76:79], v[28:31], v[144:159]
  ds_read_b64_tr_b16 v[68:69], v251 offset:36864
  ds_read_b64_tr_b16 v[70:71], v251 offset:37888
  s_waitcnt lgkmcnt(11)
  v_mfma_f32_32x32x16_bf16 v[112:127], v[32:35], v[16:19], v[112:127]
  ds_read_b128 v[24:27], v247 offset:32768
  ds_read_b64_tr_b16 v[40:41], v249 offset:40960
  ds_read_b64_tr_b16 v[42:43], v249 offset:41984
  s_waitcnt lgkmcnt(12)
  v_mfma_f32_32x32x16_bf16 v[128:143], v[48:51], v[16:19], v[128:143]
  ds_read_b64_tr_b16 v[56:57], v250 offset:40960
  ds_read_b64_tr_b16 v[58:59], v250 offset:41984
  s_waitcnt lgkmcnt(12)
  v_mfma_f32_32x32x16_bf16 v[144:159], v[64:67], v[16:19], v[144:159]
  ds_read_b64_tr_b16 v[72:73], v251 offset:40960
  ds_read_b64_tr_b16 v[74:75], v251 offset:41984
  s_waitcnt lgkmcnt(11)
  v_mfma_f32_32x32x16_bf16 v[112:127], v[36:39], v[20:23], v[112:127]
  ds_read_b128 v[28:31], v248 offset:32768
  ds_read_b64_tr_b16 v[44:45], v249 offset:45056
  ds_read_b64_tr_b16 v[46:47], v249 offset:46080
  s_waitcnt lgkmcnt(12)
  v_mfma_f32_32x32x16_bf16 v[128:143], v[52:55], v[20:23], v[128:143]
  ds_read_b64_tr_b16 v[60:61], v250 offset:45056
  ds_read_b64_tr_b16 v[62:63], v250 offset:46080
  s_waitcnt lgkmcnt(12)
  v_mfma_f32_32x32x16_bf16 v[144:159], v[68:71], v[20:23], v[144:159]
  ds_read_b64_tr_b16 v[76:77], v251 offset:45056
  ds_read_b64_tr_b16 v[78:79], v251 offset:46080
  s_waitcnt lgkmcnt(11)
  v_mfma_f32_32x32x16_bf16 v[112:127], v[40:43], v[24:27], v[112:127]
  s_waitcnt lgkmcnt(9)
  v_mfma_f32_32x32x16_bf16 v[128:143], v[56:59], v[24:27], v[128:143]
  s_waitcnt lgkmcnt(7)
  v_mfma_f32_32x32x16_bf16 v[144:159], v[72:75], v[24:27], v[144:159]
  s_waitcnt lgkmcnt(0)
  s_barrier
  v_add_u32 v245, 32768, v245
  v_add_u32 v246, 32768, v246
  v_add_u32 v247, 32768, v247
  v_add_u32 v248, 32768, v248
  v_add_u32 v249, 32768, v249
  v_add_u32 v250, 32768, v250
  v_add_u32 v251, 32768, v251
  ds_read_b128 v[16:19], v245 offset:32768
  ds_read_b64_tr_b16 v[32:33], v249 offset:32768
  ds_read_b64_tr_b16 v[34:35], v249 offset:33792
  ds_read_b64_tr_b16 v[48:49], v250 offset:32768
  ds_read_b64_tr_b16 v[50:51], v250 offset:33792
  ds_read_b64_tr_b16 v[64:65], v251 offset:32768
  ds_read_b64_tr_b16 v[66:67], v251 offset:33792
  v_mfma_f32_32x32x16_bf16 v[112:127], v[44:47], v[28:31], v[112:127]
  ds_read_b128 v[20:23], v246 offset:32768
  ds_read_b64_tr_b16 v[36:37], v249 offset:36864
  ds_read_b64_tr_b16 v[38:39], v249 offset:37888
  v_mfma_f32_32x32x16_bf16 v[128:143], v[60:63], v[28:31], v[128:143]
  ds_read_b64_tr_b16 v[52:53], v250 offset:36864
  ds_read_b64_tr_b16 v[54:55], v250 offset:37888
  v_mfma_f32_32x32x16_bf16 v[144:159], v[76:79], v[28:31], v[144:159]
  ds_read_b64_tr_b16 v[68:69], v251 offset:36864
  ds_read_b64_tr_b16 v[70:71], v251 offset:37888
  s_waitcnt lgkmcnt(11)
  v_mfma_f32_32x32x16_bf16 v[112:127], v[32:35], v[16:19], v[112:127]
  ds_read_b128 v[24:27], v247 offset:32768
  ds_read_b64_tr_b16 v[40:41], v249 offset:40960
  ds_read_b64_tr_b16 v[42:43], v249 offset:41984
  s_waitcnt lgkmcnt(12)
  v_mfma_f32_32x32x16_bf16 v[128:143], v[48:51], v[16:19], v[128:143]
  ds_read_b64_tr_b16 v[56:57], v250 offset:40960
  ds_read_b64_tr_b16 v[58:59], v250 offset:41984
  s_waitcnt lgkmcnt(12)
  v_mfma_f32_32x32x16_bf16 v[144:159], v[64:67], v[16:19], v[144:159]
  ds_read_b64_tr_b16 v[72:73], v251 offset:40960
  ds_read_b64_tr_b16 v[74:75], v251 offset:41984
  s_waitcnt lgkmcnt(11)
  v_mfma_f32_32x32x16_bf16 v[112:127], v[36:39], v[20:23], v[112:127]
  ds_read_b128 v[28:31], v248 offset:32768
  ds_read_b64_tr_b16 v[44:45], v249 offset:45056
  ds_read_b64_tr_b16 v[46:47], v249 offset:46080
  s_waitcnt lgkmcnt(12)
  v_mfma_f32_32x32x16_bf16 v[128:143], v[52:55], v[20:23], v[128:143]
  ds_read_b64_tr_b16 v[60:61], v250 offset:45056
  ds_read_b64_tr_b16 v[62:63], v250 offset:46080
  s_waitcnt lgkmcnt(12)
  v_mfma_f32_32x32x16_bf16 v[144:159], v[68:71], v[20:23], v[144:159]
  ds_read_b64_tr_b16 v[76:77], v251 offset:45056
  ds_read_b64_tr_b16 v[78:79], v251 offset:46080
  s_waitcnt lgkmcnt(11)
  v_mfma_f32_32x32x16_bf16 v[112:127], v[40:43], v[24:27], v[112:127]
  s_waitcnt lgkmcnt(9)
  v_mfma_f32_32x32x16_bf16 v[128:143], v[56:59], v[24:27], v[128:143]
  s_waitcnt lgkmcnt(7)
  v_mfma_f32_32x32x16_bf16 v[144:159], v[72:75], v[24:27], v[144:159]
  s_waitcnt lgkmcnt(0)
  s_barrier
  v_subrev_u32 v245, 32768, v245
  v_subrev_u32 v246, 32768, v246
  v_subrev_u32 v247, 32768, v247
  v_subrev_u32 v248, 32768, v248
  v_subrev_u32 v249, 32768, v249
  v_subrev_u32 v250, 32768, v250
  v_subrev_u32 v251, 32768, v251
  ds_read_b128 v[16:19], v245 offset:0
  ds_read_b64_tr_b16 v[32:33], v249 offset:0
  ds_read_b64_tr_b16 v[34:35], v249 offset:1024
  ds_read_b64_tr_b16 v[48:49], v250 offset:0
  ds_read_b64_tr_b16 v[50:51], v250 offset:1024
  ds_read_b64_tr_b16 v[64:65], v251 offset:0
  ds_read_b64_tr_b16 v[66:67], v251 offset:1024
  v_mfma_f32_32x32x16_bf16 v[112:127], v[44:47], v[28:31], v[112:127]
  ds_read_b128 v[20:23], v246 offset:0
  ds_read_b64_tr_b16 v[36:37], v249 offset:4096
  ds_read_b64_tr_b16 v[38:39], v249 offset:5120
  v_mfma_f32_32x32x16_bf16 v[128:143], v[60:63], v[28:31], v[128:143]
  ds_read_b64_tr_b16 v[52:53], v250 offset:4096
  ds_read_b64_tr_b16 v[54:55], v250 offset:5120
  v_mfma_f32_32x32x16_bf16 v[144:159], v[76:79], v[28:31], v[144:159]
  ds_read_b64_tr_b16 v[68:69], v251 offset:4096
  ds_read_b64_tr_b16 v[70:71], v251 offset:5120
  s_waitcnt lgkmcnt(11)
  v_mfma_f32_32x32x16_bf16 v[112:127], v[32:35], v[16:19], v[112:127]
  ds_read_b128 v[24:27], v247 offset:0
  ds_read_b64_tr_b16 v[40:41], v249 offset:8192
  ds_read_b64_tr_b16 v[42:43], v249 offset:9216
  s_waitcnt lgkmcnt(12)
  v_mfma_f32_32x32x16_bf16 v[128:143], v[48:51], v[16:19], v[128:143]
  ds_read_b64_tr_b16 v[56:57], v250 offset:8192
  ds_read_b64_tr_b16 v[58:59], v250 offset:9216
  s_waitcnt lgkmcnt(12)
  v_mfma_f32_32x32x16_bf16 v[144:159], v[64:67], v[16:19], v[144:159]
  ds_read_b64_tr_b16 v[72:73], v251 offset:8192
  ds_read_b64_tr_b16 v[74:75], v251 offset:9216
  s_waitcnt lgkmcnt(11)
  v_mfma_f32_32x32x16_bf16 v[112:127], v[36:39], v[20:23], v[112:127]
  ds_read_b128 v[28:31], v248 offset:0
  ds_read_b64_tr_b16 v[44:45], v249 offset:12288
  ds_read_b64_tr_b16 v[46:47], v249 offset:13312
  s_waitcnt lgkmcnt(12)
  v_mfma_f32_32x32x16_bf16 v[128:143], v[52:55], v[20:23], v[128:143]
  ds_read_b64_tr_b16 v[60:61], v250 offset:12288
  ds_read_b64_tr_b16 v[62:63], v250 offset:13312
  s_waitcnt lgkmcnt(12)
  v_mfma_f32_32x32x16_bf16 v[144:159], v[68:71], v[20:23], v[144:159]
  ds_read_b64_tr_b16 v[76:77], v251 offset:12288
  ds_read_b64_tr_b16 v[78:79], v251 offset:13312
  s_waitcnt lgkmcnt(11)
  v_mfma_f32_32x32x16_bf16 v[112:127], v[40:43], v[24:27], v[112:127]
  s_waitcnt lgkmcnt(9)
  v_mfma_f32_32x32x16_bf16 v[128:143], v[56:59], v[24:27], v[128:143]
  s_waitcnt lgkmcnt(7)
  v_mfma_f32_32x32x16_bf16 v[144:159], v[72:75], v[24:27], v[144:159]
  s_waitcnt lgkmcnt(0)
  s_barrier
  ds_read_b128 v[16:19], v245 offset:32768
  ds_read_b64_tr_b16 v[32:33], v249 offset:32768
  ds_read_b64_tr_b16 v[34:35], v249 offset:33792
  ds_read_b64_tr_b16 v[48:49], v250 offset:32768
  ds_read_b64_tr_b16 v[50:51], v250 offset:33792
  ds_read_b64_tr_b16 v[64:65], v251 offset:32768
  ds_read_b64_tr_b16 v[66:67], v251 offset:33792
  v_mfma_f32_32x32x16_bf16 v[112:127], v[44:47], v[28:31], v[112:127]
  ds_read_b128 v[20:23], v246 offset:32768
  ds_read_b64_tr_b16 v[36:37], v249 offset:36864
  ds_read_b64_tr_b16 v[38:39], v249 offset:37888
  v_mfma_f32_32x32x16_bf16 v[128:143], v[60:63], v[28:31], v[128:143]
  ds_read_b64_tr_b16 v[52:53], v250 offset:36864
  ds_read_b64_tr_b16 v[54:55], v250 offset:37888
  v_mfma_f32_32x32x16_bf16 v[144:159], v[76:79], v[28:31], v[144:159]
  ds_read_b64_tr_b16 v[68:69], v251 offset:36864
  ds_read_b64_tr_b16 v[70:71], v251 offset:37888
  s_waitcnt lgkmcnt(11)
  v_mfma_f32_32x32x16_bf16 v[112:127], v[32:35], v[16:19], v[112:127]
  ds_read_b128 v[24:27], v247 offset:32768
  ds_read_b64_tr_b16 v[40:41], v249 offset:40960
  ds_read_b64_tr_b16 v[42:43], v249 offset:41984
  s_waitcnt lgkmcnt(12)
  v_mfma_f32_32x32x16_bf16 v[128:143], v[48:51], v[16:19], v[128:143]
  ds_read_b64_tr_b16 v[56:57], v250 offset:40960
  ds_read_b64_tr_b16 v[58:59], v250 offset:41984
  s_waitcnt lgkmcnt(12)
  v_mfma_f32_32x32x16_bf16 v[144:159], v[64:67], v[16:19], v[144:159]
  ds_read_b64_tr_b16 v[72:73], v251 offset:40960
  ds_read_b64_tr_b16 v[74:75], v251 offset:41984
  s_waitcnt lgkmcnt(11)
  v_mfma_f32_32x32x16_bf16 v[112:127], v[36:39], v[20:23], v[112:127]
  ds_read_b128 v[28:31], v248 offset:32768
  ds_read_b64_tr_b16 v[44:45], v249 offset:45056
  ds_read_b64_tr_b16 v[46:47], v249 offset:46080
  s_waitcnt lgkmcnt(12)
  v_mfma_f32_32x32x16_bf16 v[128:143], v[52:55], v[20:23], v[128:143]
  ds_read_b64_tr_b16 v[60:61], v250 offset:45056
  ds_read_b64_tr_b16 v[62:63], v250 offset:46080
  s_waitcnt lgkmcnt(12)
  v_mfma_f32_32x32x16_bf16 v[144:159], v[68:71], v[20:23], v[144:159]
  ds_read_b64_tr_b16 v[76:77], v251 offset:45056
  ds_read_b64_tr_b16 v[78:79], v251 offset:46080
  s_waitcnt lgkmcnt(11)
  v_mfma_f32_32x32x16_bf16 v[112:127], v[40:43], v[24:27], v[112:127]
  s_waitcnt lgkmcnt(9)
  v_mfma_f32_32x32x16_bf16 v[128:143], v[56:59], v[24:27], v[128:143]
  s_waitcnt lgkmcnt(7)
  v_mfma_f32_32x32x16_bf16 v[144:159], v[72:75], v[24:27], v[144:159]
  s_waitcnt lgkmcnt(0)
  s_barrier
  v_add_u32 v245, 32768, v245
  v_add_u32 v246, 32768, v246
  v_add_u32 v247, 32768, v247
  v_add_u32 v248, 32768, v248
  v_add_u32 v249, 32768, v249
  v_add_u32 v250, 32768, v250
  v_add_u32 v251, 32768, v251
  ds_read_b128 v[16:19], v245 offset:32768
  ds_read_b64_tr_b16 v[32:33], v249 offset:32768
  ds_read_b64_tr_b16 v[34:35], v249 offset:33792
  ds_read_b64_tr_b16 v[48:49], v250 offset:32768
  ds_read_b64_tr_b16 v[50:51], v250 offset:33792
  ds_read_b64_tr_b16 v[64:65], v251 offset:32768
  ds_read_b64_tr_b16 v[66:67], v251 offset:33792
  v_mfma_f32_32x32x16_bf16 v[112:127], v[44:47], v[28:31], v[112:127]
  ds_read_b128 v[20:23], v246 offset:32768
  ds_read_b64_tr_b16 v[36:37], v249 offset:36864
  ds_read_b64_tr_b16 v[38:39], v249 offset:37888
  v_mfma_f32_32x32x16_bf16 v[128:143], v[60:63], v[28:31], v[128:143]
  ds_read_b64_tr_b16 v[52:53], v250 offset:36864
  ds_read_b64_tr_b16 v[54:55], v250 offset:37888
  v_mfma_f32_32x32x16_bf16 v[144:159], v[76:79], v[28:31], v[144:159]
  ds_read_b64_tr_b16 v[68:69], v251 offset:36864
  ds_read_b64_tr_b16 v[70:71], v251 offset:37888
  s_waitcnt lgkmcnt(11)
  v_mfma_f32_32x32x16_bf16 v[112:127], v[32:35], v[16:19], v[112:127]
  ds_read_b128 v[24:27], v247 offset:32768
  ds_read_b64_tr_b16 v[40:41], v249 offset:40960
  ds_read_b64_tr_b16 v[42:43], v249 offset:41984
  s_waitcnt lgkmcnt(12)
  v_mfma_f32_32x32x16_bf16 v[128:143], v[48:51], v[16:19], v[128:143]
  ds_read_b64_tr_b16 v[56:57], v250 offset:40960
  ds_read_b64_tr_b16 v[58:59], v250 offset:41984
  s_waitcnt lgkmcnt(12)
  v_mfma_f32_32x32x16_bf16 v[144:159], v[64:67], v[16:19], v[144:159]
  ds_read_b64_tr_b16 v[72:73], v251 offset:40960
  ds_read_b64_tr_b16 v[74:75], v251 offset:41984
  s_waitcnt lgkmcnt(11)
  v_mfma_f32_32x32x16_bf16 v[112:127], v[36:39], v[20:23], v[112:127]
  ds_read_b128 v[28:31], v248 offset:32768
  ds_read_b64_tr_b16 v[44:45], v249 offset:45056
  ds_read_b64_tr_b16 v[46:47], v249 offset:46080
  s_waitcnt lgkmcnt(12)
  v_mfma_f32_32x32x16_bf16 v[128:143], v[52:55], v[20:23], v[128:143]
  ds_read_b64_tr_b16 v[60:61], v250 offset:45056
  ds_read_b64_tr_b16 v[62:63], v250 offset:46080
  s_waitcnt lgkmcnt(12)
  v_mfma_f32_32x32x16_bf16 v[144:159], v[68:71], v[20:23], v[144:159]
  ds_read_b64_tr_b16 v[76:77], v251 offset:45056
  ds_read_b64_tr_b16 v[78:79], v251 offset:46080
  s_waitcnt lgkmcnt(11)
  v_mfma_f32_32x32x16_bf16 v[112:127], v[40:43], v[24:27], v[112:127]
  s_waitcnt lgkmcnt(9)
  v_mfma_f32_32x32x16_bf16 v[128:143], v[56:59], v[24:27], v[128:143]
  s_waitcnt lgkmcnt(7)
  v_mfma_f32_32x32x16_bf16 v[144:159], v[72:75], v[24:27], v[144:159]
  s_waitcnt lgkmcnt(4)
  v_mfma_f32_32x32x16_bf16 v[112:127], v[44:47], v[28:31], v[112:127]
  s_waitcnt lgkmcnt(2)
  v_mfma_f32_32x32x16_bf16 v[128:143], v[60:63], v[28:31], v[128:143]
  s_waitcnt lgkmcnt(0)
  v_mfma_f32_32x32x16_bf16 v[144:159], v[76:79], v[28:31], v[144:159]
  s_barrier
  v_subrev_u32 v245, 32768, v245
  v_subrev_u32 v246, 32768, v246
  v_subrev_u32 v247, 32768, v247
  v_subrev_u32 v248, 32768, v248
  v_subrev_u32 v249, 32768, v249
  v_subrev_u32 v250, 32768, v250
  v_subrev_u32 v251, 32768, v251
  ds_read_b128 v[16:19], v245 offset:0
  ds_read_b64_tr_b16 v[32:33], v249 offset:0
  ds_read_b64_tr_b16 v[34:35], v249 offset:1024
  ds_read_b128 v[20:23], v246 offset:0
  ds_read_b64_tr_b16 v[36:37], v249 offset:4096
  ds_read_b64_tr_b16 v[38:39], v249 offset:5120
  ds_read_b128 v[24:27], v247 offset:0
  ds_read_b64_tr_b16 v[40:41], v249 offset:8192
  ds_read_b64_tr_b16 v[42:43], v249 offset:9216
  ds_read_b128 v[28:31], v248 offset:0
  ds_read_b64_tr_b16 v[44:45], v249 offset:12288
  ds_read_b64_tr_b16 v[46:47], v249 offset:13312
  ds_read_b64_tr_b16 v[48:49], v250 offset:0
  ds_read_b64_tr_b16 v[50:51], v250 offset:1024
  ds_read_b64_tr_b16 v[52:53], v250 offset:4096
  ds_read_b64_tr_b16 v[54:55], v250 offset:5120
  ds_read_b64_tr_b16 v[56:57], v250 offset:8192
  ds_read_b64_tr_b16 v[58:59], v250 offset:9216
  ds_read_b64_tr_b16 v[60:61], v250 offset:12288
  ds_read_b64_tr_b16 v[62:63], v250 offset:13312
  ds_read_b64_tr_b16 v[64:65], v251 offset:0
  ds_read_b64_tr_b16 v[66:67], v251 offset:1024
  ds_read_b64_tr_b16 v[68:69], v251 offset:4096
  ds_read_b64_tr_b16 v[70:71], v251 offset:5120
  ds_read_b64_tr_b16 v[72:73], v251 offset:8192
  ds_read_b64_tr_b16 v[74:75], v251 offset:9216
  ds_read_b64_tr_b16 v[76:77], v251 offset:12288
  ds_read_b64_tr_b16 v[78:79], v251 offset:13312
  s_waitcnt lgkmcnt(15)
  v_mfma_f32_32x32x16_bf16 v[112:127], v[32:35], v[16:19], v[112:127]
  v_mfma_f32_32x32x16_bf16 v[112:127], v[36:39], v[20:23], v[112:127]
  v_mfma_f32_32x32x16_bf16 v[112:127], v[40:43], v[24:27], v[112:127]
  v_mfma_f32_32x32x16_bf16 v[112:127], v[44:47], v[28:31], v[112:127]
  s_waitcnt lgkmcnt(14)
  v_mfma_f32_32x32x16_bf16 v[128:143], v[48:51], v[16:19], v[128:143]
  s_waitcnt lgkmcnt(12)
  v_mfma_f32_32x32x16_bf16 v[128:143], v[52:55], v[20:23], v[128:143]
  s_waitcnt lgkmcnt(10)
  v_mfma_f32_32x32x16_bf16 v[128:143], v[56:59], v[24:27], v[128:143]
  s_mov_b32 s68, 0
  s_mov_b32 s69, -1
  s_cmp_lg_u32 s4, 1.0
  s_cbranch_scc0 EL_f5112
  s_nop 1
  v_mul_f32 v112, s4, v112
  v_mul_f32 v113, s4, v113
  v_mul_f32 v114, s4, v114
  v_mul_f32 v115, s4, v115
  v_mul_f32 v116, s4, v116
  v_mul_f32 v117, s4, v117
  v_mul_f32 v118, s4, v118
  v_mul_f32 v119, s4, v119
EL_f5112:
  s_nop 1
  v_cvt_pk_bf16_f32 v112, v112, v113
  v_cvt_pk_bf16_f32 v113, v114, v115
  s_waitcnt lgkmcnt(8)
  v_mfma_f32_32x32x16_bf16 v[128:143], v[60:63], v[28:31], v[128:143]
  v_cvt_pk_bf16_f32 v114, v116, v117
  v_cvt_pk_bf16_f32 v115, v118, v119
  buffer_store_dwordx4 v[112:115], v2, s[36:39], s11 offen offset:0 sc1
  s_cmp_lg_u32 s4, 1.0
  s_cbranch_scc0 EL_f5114
  v_mul_f32 v120, s4, v120
  v_mul_f32 v121, s4, v121
  v_mul_f32 v122, s4, v122
  v_mul_f32 v123, s4, v123
  v_mul_f32 v124, s4, v124
  v_mul_f32 v125, s4, v125
  v_mul_f32 v126, s4, v126
  v_mul_f32 v127, s4, v127
EL_f5114:
  s_waitcnt lgkmcnt(6)
  v_mfma_f32_32x32x16_bf16 v[144:159], v[64:67], v[16:19], v[144:159]
  v_cvt_pk_bf16_f32 v116, v120, v121
  v_cvt_pk_bf16_f32 v117, v122, v123
  v_cvt_pk_bf16_f32 v118, v124, v125
  v_cvt_pk_bf16_f32 v119, v126, v127
  s_waitcnt lgkmcnt(4)
  v_mfma_f32_32x32x16_bf16 v[144:159], v[68:71], v[20:23], v[144:159]
  v_cndmask_b32 v118, v118, 0, s[68:69]
  v_cndmask_b32 v119, v119, 0, s[68:69]
  buffer_store_dwordx4 v[116:119], v2, s[36:39], s11 offen offset:1024 sc1
  s_add_u32 s11, s11, 131072
  v_mov_b32 v11, 0x100
  s_waitcnt lgkmcnt(2)
  v_mfma_f32_32x32x16_bf16 v[144:159], v[72:75], v[24:27], v[144:159]
  s_cmp_lg_u32 s6, 1.0
  s_cbranch_scc0 EL_f5116
  v_mul_f32 v128, s6, v128
  v_mul_f32 v129, s6, v129
  v_mul_f32 v130, s6, v130
  v_mul_f32 v131, s6, v131
  v_mul_f32 v132, s6, v132
  v_mul_f32 v133, s6, v133
  v_mul_f32 v134, s6, v134
  v_mul_f32 v135, s6, v135
EL_f5116:
  v_cvt_pk_bf16_f32 v128, v128, v129
  s_waitcnt lgkmcnt(0)
  v_mfma_f32_32x32x16_bf16 v[144:159], v[76:79], v[28:31], v[144:159]
  v_cvt_pk_bf16_f32 v129, v130, v131
  v_cvt_pk_bf16_f32 v130, v132, v133
  s_mov_b64 exec, 1
  ds_add_u32 v10, v11
  s_mov_b64 exec, -1
  v_cvt_pk_bf16_f32 v131, v134, v135
  buffer_store_dwordx4 v[128:131], v2, s[36:39], s11 offen offset:0 sc1
  s_cmp_lg_u32 s6, 1.0
  s_cbranch_scc0 EL_f5118
  v_mul_f32 v136, s6, v136
  v_mul_f32 v137, s6, v137
  v_mul_f32 v138, s6, v138
  v_mul_f32 v139, s6, v139
  v_mul_f32 v140, s6, v140
  v_mul_f32 v141, s6, v141
  v_mul_f32 v142, s6, v142
  v_mul_f32 v143, s6, v143
EL_f5118:
  v_cvt_pk_bf16_f32 v132, v136, v137
  v_cvt_pk_bf16_f32 v133, v138, v139
  v_cvt_pk_bf16_f32 v134, v140, v141
  v_cvt_pk_bf16_f32 v135, v142, v143
  v_cndmask_b32 v134, v134, 0, s[68:69]
  v_cndmask_b32 v135, v135, 0, s[68:69]
  buffer_store_dwordx4 v[132:135], v2, s[36:39], s11 offen offset:1024 sc1
  s_add_u32 s11, s11, 131072
  s_cmp_lg_u32 s14, 1.0
  s_cbranch_scc0 EL_f5120
  v_mul_f32 v144, s14, v144
  v_mul_f32 v145, s14, v145
  v_mul_f32 v146, s14, v146
  v_mul_f32 v147, s14, v147
  v_mul_f32 v148, s14, v148
  v_mul_f32 v149, s14, v149
  v_mul_f32 v150, s14, v150
  v_mul_f32 v151, s14, v151
EL_f5120:
  v_cvt_pk_bf16_f32 v144, v144, v145
  v_cvt_pk_bf16_f32 v145, v146, v147
  v_cvt_pk_bf16_f32 v146, v148, v149
  v_cvt_pk_bf16_f32 v147, v150, v151
  buffer_store_dwordx4 v[144:147], v2, s[36:39], s11 offen offset:0 sc1
  s_cmp_lg_u32 s14, 1.0
  s_cbranch_scc0 EL_f5122
  v_mul_f32 v152, s14, v152
  v_mul_f32 v153, s14, v153
  v_mul_f32 v154, s14, v154
  v_mul_f32 v155, s14, v155
  v_mul_f32 v156, s14, v156
  v_mul_f32 v157, s14, v157
  v_mul_f32 v158, s14, v158
  v_mul_f32 v159, s14, v159
EL_f5122:
  v_cvt_pk_bf16_f32 v148, v152, v153
  v_cvt_pk_bf16_f32 v149, v154, v155
  v_cvt_pk_bf16_f32 v150, v156, v157
  v_cvt_pk_bf16_f32 v151, v158, v159
  v_cndmask_b32 v150, v150, 0, s[68:69]
  v_cndmask_b32 v151, v151, 0, s[68:69]
  buffer_store_dwordx4 v[148:151], v2, s[36:39], s11 offen offset:1024 sc1
  s_branch EN_f5111
EL_f5110:
  s_cmp_eq_u32 s54, 10
  s_cbranch_scc0 EL_f5124
  s_waitcnt vmcnt(5) lgkmcnt(0)
  s_barrier
  ds_read_b128 v[16:19], v245 offset:0
  ds_read_b64_tr_b16 v[32:33], v249 offset:0
  ds_read_b64_tr_b16 v[34:35], v249 offset:1024
  ds_read_b64_tr_b16 v[48:49], v250 offset:0
  ds_read_b64_tr_b16 v[50:51], v250 offset:1024
  ds_read_b64_tr_b16 v[64:65], v251 offset:0
  ds_read_b64_tr_b16 v[66:67], v251 offset:1024
  ds_read_b128 v[20:23], v246 offset:0
  ds_read_b64_tr_b16 v[36:37], v249 offset:4096
  ds_read_b64_tr_b16 v[38:39], v249 offset:5120
  ds_read_b64_tr_b16 v[52:53], v250 offset:4096
  ds_read_b64_tr_b16 v[54:55], v250 offset:5120
  ds_read_b64_tr_b16 v[68:69], v251 offset:4096
  ds_read_b64_tr_b16 v[70:71], v251 offset:5120
  s_waitcnt lgkmcnt(11)
  v_mfma_f32_32x32x16_bf16 v[112:127], v[32:35], v[16:19], 0
  ds_read_b128 v[24:27], v247 offset:0
  ds_read_b64_tr_b16 v[40:41], v249 offset:8192
  ds_read_b64_tr_b16 v[42:43], v249 offset:9216
  s_waitcnt lgkmcnt(12)
  v_mfma_f32_32x32x16_bf16 v[128:143], v[48:51], v[16:19], 0
  ds_read_b64_tr_b16 v[56:57], v250 offset:8192
  ds_read_b64_tr_b16 v[58:59], v250 offset:9216
  s_waitcnt lgkmcnt(12)
  v_mfma_f32_32x32x16_bf16 v[144:159], v[16:19], v[64:67], 0
  ds_read_b64_tr_b16 v[72:73], v251 offset:8192
  ds_read_b64_tr_b16 v[74:75], v251 offset:9216
  s_waitcnt lgkmcnt(11)
  v_mfma_f32_32x32x16_bf16 v[112:127], v[36:39], v[20:23], v[112:127]
  ds_read_b128 v[28:31], v248 offset:0
  ds_read_b64_tr_b16 v[44:45], v249 offset:12288
  ds_read_b64_tr_b16 v[46:47], v249 offset:13312
  s_waitcnt lgkmcnt(12)
  v_mfma_f32_32x32x16_bf16 v[128:143], v[52:55], v[20:23], v[128:143]
  ds_read_b64_tr_b16 v[60:61], v250 offset:12288
  ds_read_b64_tr_b16 v[62:63], v250 offset:13312
  s_waitcnt lgkmcnt(12)
  v_mfma_f32_32x32x16_bf16 v[144:159], v[20:23], v[68:71], v[144:159]
  ds_read_b64_tr_b16 v[76:77], v251 offset:12288
  ds_read_b64_tr_b16 v[78:79], v251 offset:13312
  s_waitcnt lgkmcnt(11)
  v_mfma_f32_32x32x16_bf16 v[112:127], v[40:43], v[24:27], v[112:127]
  s_waitcnt lgkmcnt(9)
  v_mfma_f32_32x32x16_bf16 v[128:143], v[56:59], v[24:27], v[128:143]
  s_waitcnt lgkmcnt(7)
  v_mfma_f32_32x32x16_bf16 v[144:159], v[24:27], v[72:75], v[144:159]
  s_waitcnt vmcnt(0) lgkmcnt(0)
  s_barrier
  ds_read_b128 v[16:19], v245 offset:32768
  ds_read_b64_tr_b16 v[32:33], v249 offset:32768
  ds_read_b64_tr_b16 v[34:35], v249 offset:33792
  ds_read_b64_tr_b16 v[48:49], v250 offset:32768
  ds_read_b64_tr_b16 v[50:51], v250 offset:33792
  ds_read_b64_tr_b16 v[64:65], v251 offset:32768
  ds_read_b64_tr_b16 v[66:67], v251 offset:33792
  v_readfirstlane_b32 s65, v253
  s_nop 0
  s_mul_i32 s65, s65, 0x9E3779B1
  s_add_u32 s65, s65, 0x7F4A7C15
  v_mov_b32 v12, s65
  v_mov_b32 v13, s65
  v_mov_b32 v14, s65
  v_mov_b32 v15, s65
  v_mfma_f32_32x32x16_bf16 v[112:127], v[44:47], v[28:31], v[112:127]
  ds_read_b128 v[20:23], v246 offset:32768
  ds_read_b64_tr_b16 v[36:37], v249 offset:36864
  ds_read_b64_tr_b16 v[38:39], v249 offset:37888
  v_mfma_f32_32x32x16_bf16 v[128:143], v[60:63], v[28:31], v[128:143]
  ds_read_b64_tr_b16 v[52:53], v250 offset:36864
  ds_read_b64_tr_b16 v[54:55], v250 offset:37888
  v_mfma_f32_32x32x16_bf16 v[144:159], v[28:31], v[76:79], v[144:159]
  ds_read_b64_tr_b16 v[68:69], v251 offset:36864
  ds_read_b64_tr_b16 v[70:71], v251 offset:37888
  s_waitcnt lgkmcnt(11)
  v_mfma_f32_32x32x16_bf16 v[112:127], v[32:35], v[16:19], v[112:127]
  ds_read_b128 v[24:27], v247 offset:32768
  ds_read_b64_tr_b16 v[40:41], v249 offset:40960
  ds_read_b64_tr_b16 v[42:43], v249 offset:41984
  s_waitcnt lgkmcnt(12)
  v_mfma_f32_32x32x16_bf16 v[128:143], v[48:51], v[16:19], v[128:143]
  ds_read_b64_tr_b16 v[56:57], v250 offset:40960
  ds_read_b64_tr_b16 v[58:59], v250 offset:41984
  s_waitcnt lgkmcnt(12)
  v_mfma_f32_32x32x16_bf16 v[144:159], v[16:19], v[64:67], v[144:159]
  ds_read_b64_tr_b16 v[72:73], v251 offset:40960
  ds_read_b64_tr_b16 v[74:75], v251 offset:41984
  s_waitcnt lgkmcnt(11)
  v_mfma_f32_32x32x16_bf16 v[112:127], v[36:39], v[20:23], v[112:127]
  ds_read_b128 v[28:31], v248 offset:32768
  ds_read_b64_tr_b16 v[44:45], v249 offset:45056
  ds_read_b64_tr_b16 v[46:47], v249 offset:46080
  s_waitcnt lgkmcnt(12)
  v_mfma_f32_32x32x16_bf16 v[128:143], v[52:55], v[20:23], v[128:143]
  ds_read_b64_tr_b16 v[60:61], v250 offset:45056
  ds_read_b64_tr_b16 v[62:63], v250 offset:46080
  s_waitcnt lgkmcnt(12)
  v_mfma_f32_32x32x16_bf16 v[144:159], v[20:23], v[68:71], v[144:159]
  ds_read_b64_tr_b16 v[76:77], v251 offset:45056
  ds_read_b64_tr_b16 v[78:79], v251 offset:46080
  s_waitcnt lgkmcnt(11)
  v_mfma_f32_32x32x16_bf16 v[112:127], v[40:43], v[24:27], v[112:127]
  s_waitcnt lgkmcnt(9)
  v_mfma_f32_32x32x16_bf16 v[128:143], v[56:59], v[24:27], v[128:143]
  s_waitcnt lgkmcnt(7)
  v_mfma_f32_32x32x16_bf16 v[144:159], v[24:27], v[72:75], v[144:159]
  s_waitcnt lgkmcnt(0)
  s_barrier
  v_add_u32 v245, 32768, v245
  v_add_u32 v246, 32768, v246
  v_add_u32 v247, 32768, v247
  v_add_u32 v248, 32768, v248
  v_add_u32 v249, 32768, v249
  v_add_u32 v250, 32768, v250
  v_add_u32 v251, 32768, v251
  ds_read_b128 v[16:19], v245 offset:32768
  ds_read_b64_tr_b16 v[32:33], v249 offset:32768
  ds_read_b64_tr_b16 v[34:35], v249 offset:33792
  ds_read_b64_tr_b16 v[48:49], v250 offset:32768
  ds_read_b64_tr_b16 v[50:51], v250 offset:33792
  ds_read_b64_tr_b16 v[64:65], v251 offset:32768
  ds_read_b64_tr_b16 v[66:67], v251 offset:33792
  v_mfma_f32_32x32x16_bf16 v[112:127], v[44:47], v[28:31], v[112:127]
  ds_read_b128 v[20:23], v246 offset:32768
  ds_read_b64_tr_b16 v[36:37], v249 offset:36864
  ds_read_b64_tr_b16 v[38:39], v249 offset:37888
  v_mfma_f32_32x32x16_bf16 v[128:143], v[60:63], v[28:31], v[128:143]
  ds_read_b64_tr_b16 v[52:53], v250 offset:36864
  ds_read_b64_tr_b16 v[54:55], v250 offset:37888
  v_mfma_f32_32x32x16_bf16 v[144:159], v[28:31], v[76:79], v[144:159]
  ds_read_b64_tr_b16 v[68:69], v251 offset:36864
  ds_read_b64_tr_b16 v[70:71], v251 offset:37888
  s_waitcnt lgkmcnt(11)
  v_mfma_f32_32x32x16_bf16 v[112:127], v[32:35], v[16:19], v[112:127]
  ds_read_b128 v[24:27], v247 offset:32768
  ds_read_b64_tr_b16 v[40:41], v249 offset:40960
  ds_read_b64_tr_b16 v[42:43], v249 offset:41984
  s_waitcnt lgkmcnt(12)
  v_mfma_f32_32x32x16_bf16 v[128:143], v[48:51], v[16:19], v[128:143]
  ds_read_b64_tr_b16 v[56:57], v250 offset:40960
  ds_read_b64_tr_b16 v[58:59], v250 offset:41984
  s_waitcnt lgkmcnt(12)
  v_mfma_f32_32x32x16_bf16 v[144:159], v[16:19], v[64:67], v[144:159]
  ds_read_b64_tr_b16 v[72:73], v251 offset:40960
  ds_read_b64_tr_b16 v[74:75], v251 offset:41984
  s_waitcnt lgkmcnt(11)
  v_mfma_f32_32x32x16_bf16 v[112:127], v[36:39], v[20:23], v[112:127]
  ds_read_b128 v[28:31], v248 offset:32768
  ds_read_b64_tr_b16 v[44:45], v249 offset:45056
  ds_read_b64_tr_b16 v[46:47], v249 offset:46080
  s_waitcnt lgkmcnt(12)
  v_mfma_f32_32x32x16_bf16 v[128:143], v[52:55], v[20:23], v[128:143]
  ds_read_b64_tr_b16 v[60:61], v250 offset:45056
  ds_read_b64_tr_b16 v[62:63], v250 offset:46080
  s_waitcnt lgkmcnt(12)
  v_mfma_f32_32x32x16_bf16 v[144:159], v[20:23], v[68:71], v[144:159]
  ds_read_b64_tr_b16 v[76:77], v251 offset:45056
  ds_read_b64_tr_b16 v[78:79], v251 offset:46080
  s_waitcnt lgkmcnt(11)
  v_mfma_f32_32x32x16_bf16 v[112:127], v[40:43], v[24:27], v[112:127]
  s_waitcnt lgkmcnt(9)
  v_mfma_f32_32x32x16_bf16 v[128:143], v[56:59], v[24:27], v[128:143]
  s_waitcnt lgkmcnt(7)
  v_mfma_f32_32x32x16_bf16 v[144:159], v[24:27], v[72:75], v[144:159]
  s_waitcnt lgkmcnt(0)
  s_barrier
  v_subrev_u32 v245, 32768, v245
  v_subrev_u32 v246, 32768, v246
  v_subrev_u32 v247, 32768, v247
  v_subrev_u32 v248, 32768, v248
  v_subrev_u32 v249, 32768, v249
  v_subrev_u32 v250, 32768, v250
  v_subrev_u32 v251, 32768, v251
  ds_read_b128 v[16:19], v245 offset:0
  ds_read_b64_tr_b16 v[32:33], v249 offset:0
  ds_read_b64_tr_b16 v[34:35], v249 offset:1024
  ds_read_b64_tr_b16 v[48:49], v250 offset:0
  ds_read_b64_tr_b16 v[50:51], v250 offset:1024
  ds_read_b64_tr_b16 v[64:65], v251 offset:0
  ds_read_b64_tr_b16 v[66:67], v251 offset:1024
  v_mfma_f32_32x32x16_bf16 v[112:127], v[44:47], v[28:31], v[112:127]
  ds_read_b128 v[20:23], v246 offset:0
  ds_read_b64_tr_b16 v[36:37], v249 offset:4096
  ds_read_b64_tr_b16 v[38:39], v249 offset:5120
  v_mfma_f32_32x32x16_bf16 v[128:143], v[60:63], v[28:31], v[128:143]
  ds_read_b64_tr_b16 v[52:53], v250 offset:4096
  ds_read_b64_tr_b16 v[54:55], v250 offset:5120
  v_mfma_f32_32x32x16_bf16 v[144:159], v[28:31], v[76:79], v[144:159]
  ds_read_b64_tr_b16 v[68:69], v251 offset:4096
  ds_read_b64_tr_b16 v[70:71], v251 offset:5120
  s_waitcnt lgkmcnt(11)
  v_mfma_f32_32x32x16_bf16 v[112:127], v[32:35], v[16:19], v[112:127]
  ds_read_b128 v[24:27], v247 offset:0
  ds_read_b64_tr_b16 v[40:41], v249 offset:8192
  ds_read_b64_tr_b16 v[42:43], v249 offset:9216
  s_waitcnt lgkmcnt(12)
  v_mfma_f32_32x32x16_bf16 v[128:143], v[48:51], v[16:19], v[128:143]
  ds_read_b64_tr_b16 v[56:57], v250 offset:8192
  ds_read_b64_tr_b16 v[58:59], v250 offset:9216
  s_waitcnt lgkmcnt(12)
  v_mfma_f32_32x32x16_bf16 v[144:159], v[16:19], v[64:67], v[144:159]
  ds_read_b64_tr_b16 v[72:73], v251 offset:8192
  ds_read_b64_tr_b16 v[74:75], v251 offset:9216
  s_waitcnt lgkmcnt(11)
  v_mfma_f32_32x32x16_bf16 v[112:127], v[36:39], v[20:23], v[112:127]
  ds_read_b128 v[28:31], v248 offset:0
  ds_read_b64_tr_b16 v[44:45], v249 offset:12288
  ds_read_b64_tr_b16 v[46:47], v249 offset:13312
  s_waitcnt lgkmcnt(12)
  v_mfma_f32_32x32x16_bf16 v[128:143], v[52:55], v[20:23], v[128:143]
  ds_read_b64_tr_b16 v[60:61], v250 offset:12288
  ds_read_b64_tr_b16 v[62:63], v250 offset:13312
  s_waitcnt lgkmcnt(12)
  v_mfma_f32_32x32x16_bf16 v[144:159], v[20:23], v[68:71], v[144:159]
  ds_read_b64_tr_b16 v[76:77], v251 offset:12288
  ds_read_b64_tr_b16 v[78:79], v251 offset:13312
  s_waitcnt lgkmcnt(11)
  v_mfma_f32_32x32x16_bf16 v[112:127], v[40:43], v[24:27], v[112:127]
  s_waitcnt lgkmcnt(9)
  v_mfma_f32_32x32x16_bf16 v[128:143], v[56:59], v[24:27], v[128:143]
  s_waitcnt lgkmcnt(7)
  v_mfma_f32_32x32x16_bf16 v[144:159], v[24:27], v[72:75], v[144:159]
  s_waitcnt lgkmcnt(0)
  s_barrier
  ds_read_b128 v[16:19], v245 offset:32768
  ds_read_b64_tr_b16 v[32:33], v249 offset:32768
  ds_read_b64_tr_b16 v[34:35], v249 offset:33792
  ds_read_b64_tr_b16 v[48:49], v250 offset:32768
  ds_read_b64_tr_b16 v[50:51], v250 offset:33792
  ds_read_b64_tr_b16 v[64:65], v251 offset:32768
  ds_read_b64_tr_b16 v[66:67], v251 offset:33792
  v_mfma_f32_32x32x16_bf16 v[112:127], v[44:47], v[28:31], v[112:127]
  ds_read_b128 v[20:23], v246 offset:32768
  ds_read_b64_tr_b16 v[36:37], v249 offset:36864
  ds_read_b64_tr_b16 v[38:39], v249 offset:37888
  v_mfma_f32_32x32x16_bf16 v[128:143], v[60:63], v[28:31], v[128:143]
  ds_read_b64_tr_b16 v[52:53], v250 offset:36864
  ds_read_b64_tr_b16 v[54:55], v250 offset:37888
  v_mfma_f32_32x32x16_bf16 v[144:159], v[28:31], v[76:79], v[144:159]
  ds_read_b64_tr_b16 v[68:69], v251 offset:36864
  ds_read_b64_tr_b16 v[70:71], v251 offset:37888
  s_waitcnt lgkmcnt(11)
  v_mfma_f32_32x32x16_bf16 v[112:127], v[32:35], v[16:19], v[112:127]
  ds_read_b128 v[24:27], v247 offset:32768
  ds_read_b64_tr_b16 v[40:41], v249 offset:40960
  ds_read_b64_tr_b16 v[42:43], v249 offset:41984
  s_waitcnt lgkmcnt(12)
  v_mfma_f32_32x32x16_bf16 v[128:143], v[48:51], v[16:19], v[128:143]
  ds_read_b64_tr_b16 v[56:57], v250 offset:40960
  ds_read_b64_tr_b16 v[58:59], v250 offset:41984
  s_waitcnt lgkmcnt(12)
  v_mfma_f32_32x32x16_bf16 v[144:159], v[16:19], v[64:67], v[144:159]
  ds_read_b64_tr_b16 v[72:73], v251 offset:40960
  ds_read_b64_tr_b16 v[74:75], v251 offset:41984
  s_waitcnt lgkmcnt(11)
  v_mfma_f32_32x32x16_bf16 v[112:127], v[36:39], v[20:23], v[112:127]
  ds_read_b128 v[28:31], v248 offset:32768
  ds_read_b64_tr_b16 v[44:45], v249 offset:45056
  ds_read_b64_tr_b16 v[46:47], v249 offset:46080
  s_waitcnt lgkmcnt(12)
  v_mfma_f32_32x32x16_bf16 v[128:143], v[52:55], v[20:23], v[128:143]
  ds_read_b64_tr_b16 v[60:61], v250 offset:45056
  ds_read_b64_tr_b16 v[62:63], v250 offset:46080
  s_waitcnt lgkmcnt(12)
  v_mfma_f32_32x32x16_bf16 v[144:159], v[20:23], v[68:71], v[144:159]
  ds_read_b64_tr_b16 v[76:77], v251 offset:45056
  ds_read_b64_tr_b16 v[78:79], v251 offset:46080
  s_waitcnt lgkmcnt(11)
  v_mfma_f32_32x32x16_bf16 v[112:127], v[40:43], v[24:27], v[112:127]
  s_waitcnt lgkmcnt(9)
  v_mfma_f32_32x32x16_bf16 v[128:143], v[56:59], v[24:27], v[128:143]
  s_waitcnt lgkmcnt(7)
  v_mfma_f32_32x32x16_bf16 v[144:159], v[24:27], v[72:75], v[144:159]
  s_waitcnt lgkmcnt(0)
  s_barrier
  v_add_u32 v245, 32768, v245
  v_add_u32 v246, 32768, v246
  v_add_u32 v247, 32768, v247
  v_add_u32 v248, 32768, v248
  v_add_u32 v249, 32768, v249
  v_add_u32 v250, 32768, v250
  v_add_u32 v251, 32768, v251
  ds_read_b128 v[16:19], v245 offset:32768
  ds_read_b64_tr_b16 v[32:33], v249 offset:32768
  ds_read_b64_tr_b16 v[34:35], v249 offset:33792
  ds_read_b64_tr_b16 v[48:49], v250 offset:32768
  ds_read_b64_tr_b16 v[50:51], v250 offset:33792
  ds_read_b64_tr_b16 v[64:65], v251 offset:32768
  ds_read_b64_tr_b16 v[66:67], v251 offset:33792
  v_mfma_f32_32x32x16_bf16 v[112:127], v[44:47], v[28:31], v[112:127]
  ds_read_b128 v[20:23], v246 offset:32768
  ds_read_b64_tr_b16 v[36:37], v249 offset:36864
  ds_read_b64_tr_b16 v[38:39], v249 offset:37888
  v_mfma_f32_32x32x16_bf16 v[128:143], v[60:63], v[28:31], v[128:143]
  ds_read_b64_tr_b16 v[52:53], v250 offset:36864
  ds_read_b64_tr_b16 v[54:55], v250 offset:37888
  v_mfma_f32_32x32x16_bf16 v[144:159], v[28:31], v[76:79], v[144:159]
  ds_read_b64_tr_b16 v[68:69], v251 offset:36864
  ds_read_b64_tr_b16 v[70:71], v251 offset:37888
  s_waitcnt lgkmcnt(11)
  v_mfma_f32_32x32x16_bf16 v[112:127], v[32:35], v[16:19], v[112:127]
  ds_read_b128 v[24:27], v247 offset:32768
  ds_read_b64_tr_b16 v[40:41], v249 offset:40960
  ds_read_b64_tr_b16 v[42:43], v249 offset:41984
  s_waitcnt lgkmcnt(12)
  v_mfma_f32_32x32x16_bf16 v[128:143], v[48:51], v[16:19], v[128:143]
  ds_read_b64_tr_b16 v[56:57], v250 offset:40960
  ds_read_b64_tr_b16 v[58:59], v250 offset:41984
  s_waitcnt lgkmcnt(12)
  v_mfma_f32_32x32x16_bf16 v[144:159], v[16:19], v[64:67], v[144:159]
  ds_read_b64_tr_b16 v[72:73], v251 offset:40960
  ds_read_b64_tr_b16 v[74:75], v251 offset:41984
  s_waitcnt lgkmcnt(11)
  v_mfma_f32_32x32x16_bf16 v[112:127], v[36:39], v[20:23], v[112:127]
  ds_read_b128 v[28:31], v248 offset:32768
  ds_read_b64_tr_b16 v[44:45], v249 offset:45056
  ds_read_b64_tr_b16 v[46:47], v249 offset:46080
  s_waitcnt lgkmcnt(12)
  v_mfma_f32_32x32x16_bf16 v[128:143], v[52:55], v[20:23], v[128:143]
  ds_read_b64_tr_b16 v[60:61], v250 offset:45056
  ds_read_b64_tr_b16 v[62:63], v250 offset:46080
  s_waitcnt lgkmcnt(12)
  v_mfma_f32_32x32x16_bf16 v[144:159], v[20:23], v[68:71], v[144:159]
  ds_read_b64_tr_b16 v[76:77], v251 offset:45056
  ds_read_b64_tr_b16 v[78:79], v251 offset:46080
  s_waitcnt lgkmcnt(11)
  v_mfma_f32_32x32x16_bf16 v[112:127], v[40:43], v[24:27], v[112:127]
  s_waitcnt lgkmcnt(9)
  v_mfma_f32_32x32x16_bf16 v[128:143], v[56:59], v[24:27], v[128:143]
  s_waitcnt lgkmcnt(7)
  v_mfma_f32_32x32x16_bf16 v[144:159], v[24:27], v[72:75], v[144:159]
  s_waitcnt lgkmcnt(4)
  v_mfma_f32_32x32x16_bf16 v[112:127], v[44:47], v[28:31], v[112:127]
  s_waitcnt lgkmcnt(2)
  v_mfma_f32_32x32x16_bf16 v[128:143], v[60:63], v[28:31], v[128:143]
  s_waitcnt lgkmcnt(0)
  v_mfma_f32_32x32x16_bf16 v[144:159], v[28:31], v[76:79], v[144:159]
  s_barrier
  v_subrev_u32 v245, 32768, v245
  v_subrev_u32 v246, 32768, v246
  v_subrev_u32 v247, 32768, v247
  v_subrev_u32 v248, 32768, v248
  v_subrev_u32 v249, 32768, v249
  v_subrev_u32 v250, 32768, v250
  v_subrev_u32 v251, 32768, v251
  ds_read_b128 v[16:19], v245 offset:0
  ds_read_b64_tr_b16 v[32:33], v249 offset:0
  ds_read_b64_tr_b16 v[34:35], v249 offset:1024
  ds_read_b128 v[20:23], v246 offset:0
  ds_read_b64_tr_b16 v[36:37], v249 offset:4096
  ds_read_b64_tr_b16 v[38:39], v249 offset:5120
  ds_read_b128 v[24:27], v247 offset:0
  ds_read_b64_tr_b16 v[40:41], v249 offset:8192
  ds_read_b64_tr_b16 v[42:43], v249 offset:9216
  ds_read_b128 v[28:31], v248 offset:0
  ds_read_b64_tr_b16 v[44:45], v249 offset:12288
  ds_read_b64_tr_b16 v[46:47], v249 offset:13312
  ds_read_b64_tr_b16 v[48:49], v250 offset:0
  ds_read_b64_tr_b16 v[50:51], v250 offset:1024
  ds_read_b64_tr_b16 v[52:53], v250 offset:4096
  ds_read_b64_tr_b16 v[54:55], v250 offset:5120
  ds_read_b64_tr_b16 v[56:57], v250 offset:8192
  ds_read_b64_tr_b16 v[58:59], v250 offset:9216
  ds_read_b64_tr_b16 v[60:61], v250 offset:12288
  ds_read_b64_tr_b16 v[62:63], v250 offset:13312
  ds_read_b64_tr_b16 v[64:65], v251 offset:0
  ds_read_b64_tr_b16 v[66:67], v251 offset:1024
  ds_read_b64_tr_b16 v[68:69], v251 offset:4096
  ds_read_b64_tr_b16 v[70:71], v251 offset:5120
  ds_read_b64_tr_b16 v[72:73], v251 offset:8192
  ds_read_b64_tr_b16 v[74:75], v251 offset:9216
  ds_read_b64_tr_b16 v[76:77], v251 offset:12288
  ds_read_b64_tr_b16 v[78:79], v251 offset:13312
  s_waitcnt lgkmcnt(15)
  v_mfma_f32_32x32x16_bf16 v[112:127], v[32:35], v[16:19], v[112:127]
  v_mfma_f32_32x32x16_bf16 v[112:127], v[36:39], v[20:23], v[112:127]
  v_mfma_f32_32x32x16_bf16 v[112:127], v[40:43], v[24:27], v[112:127]
  v_mfma_f32_32x32x16_bf16 v[112:127], v[44:47], v[28:31], v[112:127]
  s_waitcnt lgkmcnt(14)
  v_mfma_f32_32x32x16_bf16 v[128:143], v[48:51], v[16:19], v[128:143]
  s_waitcnt lgkmcnt(12)
  v_mfma_f32_32x32x16_bf16 v[128:143], v[52:55], v[20:23], v[128:143]
  s_waitcnt lgkmcnt(10)
  v_mfma_f32_32x32x16_bf16 v[128:143], v[56:59], v[24:27], v[128:143]
  s_mov_b32 s68, 0
  s_mov_b32 s69, -1
  s_nop 3
  v_cvt_pk_bf16_f32 v112, v112, v113
  v_cvt_pk_bf16_f32 v113, v114, v115
  s_waitcnt lgkmcnt(8)
  v_mfma_f32_32x32x16_bf16 v[128:143], v[60:63], v[28:31], v[128:143]
  v_cvt_pk_bf16_f32 v114, v116, v117
  v_cvt_pk_bf16_f32 v115, v118, v119
  buffer_store_dwordx4 v[112:115], v2, s[36:39], s11 offen offset:0 sc1
  v_cvt_pk_bf16_f32 v116, v120, v121
  s_waitcnt lgkmcnt(6)
  v_mfma_f32_32x32x16_bf16 v[144:159], v[16:19], v[64:67], v[144:159]
  v_cvt_pk_bf16_f32 v117, v122, v123
  v_cvt_pk_bf16_f32 v118, v124, v125
  v_cvt_pk_bf16_f32 v119, v126, v127
  v_cndmask_b32 v118, v118, 0, s[68:69]
  s_waitcnt lgkmcnt(4)
  v_mfma_f32_32x32x16_bf16 v[144:159], v[20:23], v[68:71], v[144:159]
  v_cndmask_b32 v119, v119, 0, s[68:69]
  buffer_store_dwordx4 v[116:119], v2, s[36:39], s11 offen offset:1024 sc1
  s_add_u32 s11, s11, 131072
  v_mov_b32 v11, 0x100
  s_waitcnt lgkmcnt(2)
  v_mfma_f32_32x32x16_bf16 v[144:159], v[24:27], v[72:75], v[144:159]
  v_cvt_pk_bf16_f32 v128, v128, v129
  v_cvt_pk_bf16_f32 v129, v130, v131
  s_waitcnt lgkmcnt(0)
  v_mfma_f32_32x32x16_bf16 v[144:159], v[28:31], v[76:79], v[144:159]
  v_cvt_pk_bf16_f32 v130, v132, v133
  v_cvt_pk_bf16_f32 v131, v134, v135
  s_mov_b64 exec, 1
  ds_add_u32 v10, v11
  s_mov_b64 exec, -1
  buffer_store_dwordx4 v[128:131], v2, s[36:39], s11 offen offset:0 sc1
  v_cvt_pk_bf16_f32 v132, v136, v137
  v_cvt_pk_bf16_f32 v133, v138, v139
  v_cvt_pk_bf16_f32 v134, v140, v141
  v_cvt_pk_bf16_f32 v135, v142, v143
  v_cndmask_b32 v134, v134, 0, s[68:69]
  v_cndmask_b32 v135, v135, 0, s[68:69]
  buffer_store_dwordx4 v[132:135], v2, s[36:39], s11 offen offset:1024 sc1
  s_add_u32 s11, s11, 131072
  s_mov_b32 s68, 0xf0000000
  s_mov_b32 s69, 0xf0000000
  v_cvt_pk_bf16_f32 v144, v144, v145
  v_cvt_pk_bf16_f32 v145, v146, v147
  v_cvt_pk_bf16_f32 v146, v148, v149
  v_cvt_pk_bf16_f32 v147, v150, v151
  v_cndmask_b32 v144, v144, v252, s[68:69]
  v_cndmask_b32 v145, v145, v252, s[68:69]
  v_cndmask_b32 v146, v146, v252, s[68:69]
  v_cndmask_b32 v147, v147, v252, s[68:69]
  buffer_store_dwordx4 v[144:147], v2, s[36:39], s11 offen offset:0 sc1
  v_cvt_pk_bf16_f32 v148, v152, v153
  v_cvt_pk_bf16_f32 v149, v154, v155
  v_cvt_pk_bf16_f32 v150, v156, v157
  v_cvt_pk_bf16_f32 v151, v158, v159
  v_cndmask_b32 v148, v148, v252, s[68:69]
  v_cndmask_b32 v149, v149, v252, s[68:69]
  v_cndmask_b32 v150, v150, v252, s[68:69]
  v_cndmask_b32 v151, v151, v252, s[68:69]
  buffer_store_dwordx4 v[148:151], v2, s[36:39], s11 offen offset:1024 sc1
  s_branch EN_f5125
EL_f5124:
  s_waitcnt vmcnt(5) lgkmcnt(0)
  s_barrier
  ds_read_b128 v[16:19], v245 offset:0
  ds_read_b64_tr_b16 v[32:33], v249 offset:0
  ds_read_b64_tr_b16 v[34:35], v249 offset:1024
  ds_read_b64_tr_b16 v[48:49], v250 offset:0
  ds_read_b64_tr_b16 v[50:51], v250 offset:1024
  ds_read_b64_tr_b16 v[64:65], v251 offset:0
  ds_read_b64_tr_b16 v[66:67], v251 offset:1024
  ds_read_b128 v[20:23], v246 offset:0
  ds_read_b64_tr_b16 v[36:37], v249 offset:4096
  ds_read_b64_tr_b16 v[38:39], v249 offset:5120
  ds_read_b64_tr_b16 v[52:53], v250 offset:4096
  ds_read_b64_tr_b16 v[54:55], v250 offset:5120
  ds_read_b64_tr_b16 v[68:69], v251 offset:4096
  ds_read_b64_tr_b16 v[70:71], v251 offset:5120
  s_waitcnt lgkmcnt(11)
  v_mfma_f32_32x32x16_bf16 v[112:127], v[16:19], v[32:35], 0
  ds_read_b128 v[24:27], v247 offset:0
  ds_read_b64_tr_b16 v[40:41], v249 offset:8192
  ds_read_b64_tr_b16 v[42:43], v249 offset:9216
  s_waitcnt lgkmcnt(12)
  v_mfma_f32_32x32x16_bf16 v[128:143], v[16:19], v[48:51], 0
  ds_read_b64_tr_b16 v[56:57], v250 offset:8192
  ds_read_b64_tr_b16 v[58:59], v250 offset:9216
  s_waitcnt lgkmcnt(12)
  v_mfma_f32_32x32x16_bf16 v[144:159], v[16:19], v[64:67], 0
  ds_read_b64_tr_b16 v[72:73], v251 offset:8192
  ds_read_b64_tr_b16 v[74:75], v251 offset:9216
  s_waitcnt lgkmcnt(11)
  v_mfma_f32_32x32x16_bf16 v[112:127], v[20:23], v[36:39], v[112:127]
  ds_read_b128 v[28:31], v248 offset:0
  ds_read_b64_tr_b16 v[44:45], v249 offset:12288
  ds_read_b64_tr_b16 v[46:47], v249 offset:13312
  s_waitcnt lgkmcnt(12)
  v_mfma_f32_32x32x16_bf16 v[128:143], v[20:23], v[52:55], v[128:143]
  ds_read_b64_tr_b16 v[60:61], v250 offset:12288
  ds_read_b64_tr_b16 v[62:63], v250 offset:13312
  s_waitcnt lgkmcnt(12)
  v_mfma_f32_32x32x16_bf16 v[144:159], v[20:23], v[68:71], v[144:159]
  ds_read_b64_tr_b16 v[76:77], v251 offset:12288
  ds_read_b64_tr_b16 v[78:79], v251 offset:13312
  s_waitcnt lgkmcnt(11)
  v_mfma_f32_32x32x16_bf16 v[112:127], v[24:27], v[40:43], v[112:127]
  s_waitcnt lgkmcnt(9)
  v_mfma_f32_32x32x16_bf16 v[128:143], v[24:27], v[56:59], v[128:143]
  s_waitcnt lgkmcnt(7)
  v_mfma_f32_32x32x16_bf16 v[144:159], v[24:27], v[72:75], v[144:159]
  s_waitcnt vmcnt(0) lgkmcnt(0)
  s_barrier
  ds_read_b128 v[16:19], v245 offset:32768
  ds_read_b64_tr_b16 v[32:33], v249 offset:32768
  ds_read_b64_tr_b16 v[34:35], v249 offset:33792
  ds_read_b64_tr_b16 v[48:49], v250 offset:32768
  ds_read_b64_tr_b16 v[50:51], v250 offset:33792
  ds_read_b64_tr_b16 v[64:65], v251 offset:32768
  ds_read_b64_tr_b16 v[66:67], v251 offset:33792
  v_readfirstlane_b32 s65, v253
  s_nop 0
  s_mul_i32 s65, s65, 0x9E3779B1
  s_add_u32 s65, s65, 0x7F4A7C15
  v_mov_b32 v12, s65
  v_mov_b32 v13, s65
  v_mov_b32 v14, s65
  v_mov_b32 v15, s65
  v_mfma_f32_32x32x16_bf16 v[112:127], v[28:31], v[44:47], v[112:127]
  ds_read_b128 v[20:23], v246 offset:32768
  ds_read_b64_tr_b16 v[36:37], v249 offset:36864
  ds_read_b64_tr_b16 v[38:39], v249 offset:37888
  v_mfma_f32_32x32x16_bf16 v[128:143], v[28:31], v[60:63], v[128:143]
  ds_read_b64_tr_b16 v[52:53], v250 offset:36864
  ds_read_b64_tr_b16 v[54:55], v250 offset:37888
  v_mfma_f32_32x32x16_bf16 v[144:159], v[28:31], v[76:79], v[144:159]
  ds_read_b64_tr_b16 v[68:69], v251 offset:36864
  ds_read_b64_tr_b16 v[70:71], v251 offset:37888
  s_waitcnt lgkmcnt(11)
  v_mfma_f32_32x32x16_bf16 v[112:127], v[16:19], v[32:35], v[112:127]
  ds_read_b128 v[24:27], v247 offset:32768
  ds_read_b64_tr_b16 v[40:41], v249 offset:40960
  ds_read_b64_tr_b16 v[42:43], v249 offset:41984
  s_waitcnt lgkmcnt(12)
  v_mfma_f32_32x32x16_bf16 v[128:143], v[16:19], v[48:51], v[128:143]
  ds_read_b64_tr_b16 v[56:57], v250 offset:40960
  ds_read_b64_tr_b16 v[58:59], v250 offset:41984
  s_waitcnt lgkmcnt(12)
  v_mfma_f32_32x32x16_bf16 v[144:159], v[16:19], v[64:67], v[144:159]
  ds_read_b64_tr_b16 v[72:73], v251 offset:40960
  ds_read_b64_tr_b16 v[74:75], v251 offset:41984
  s_waitcnt lgkmcnt(11)
  v_mfma_f32_32x32x16_bf16 v[112:127], v[20:23], v[36:39], v[112:127]
  ds_read_b128 v[28:31], v248 offset:32768
  ds_read_b64_tr_b16 v[44:45], v249 offset:45056
  ds_read_b64_tr_b16 v[46:47], v249 offset:46080
  s_waitcnt lgkmcnt(12)
  v_mfma_f32_32x32x16_bf16 v[128:143], v[20:23], v[52:55], v[128:143]
  ds_read_b64_tr_b16 v[60:61], v250 offset:45056
  ds_read_b64_tr_b16 v[62:63], v250 offset:46080
  s_waitcnt lgkmcnt(12)
  v_mfma_f32_32x32x16_bf16 v[144:159], v[20:23], v[68:71], v[144:159]
  ds_read_b64_tr_b16 v[76:77], v251 offset:45056
  ds_read_b64_tr_b16 v[78:79], v251 offset:46080
  s_waitcnt lgkmcnt(11)
  v_mfma_f32_32x32x16_bf16 v[112:127], v[24:27], v[40:43], v[112:127]
  s_waitcnt lgkmcnt(9)
  v_mfma_f32_32x32x16_bf16 v[128:143], v[24:27], v[56:59], v[128:143]
  s_waitcnt lgkmcnt(7)
  v_mfma_f32_32x32x16_bf16 v[144:159], v[24:27], v[72:75], v[144:159]
  s_waitcnt lgkmcnt(0)
  s_barrier
  v_add_u32 v245, 32768, v245
  v_add_u32 v246, 32768, v246
  v_add_u32 v247, 32768, v247
  v_add_u32 v248, 32768, v248
  v_add_u32 v249, 32768, v249
  v_add_u32 v250, 32768, v250
  v_add_u32 v251, 32768, v251
  ds_read_b128 v[16:19], v245 offset:32768
  ds_read_b64_tr_b16 v[32:33], v249 offset:32768
  ds_read_b64_tr_b16 v[34:35], v249 offset:33792
  ds_read_b64_tr_b16 v[48:49], v250 offset:32768
  ds_read_b64_tr_b16 v[50:51], v250 offset:33792
  ds_read_b64_tr_b16 v[64:65], v251 offset:32768
  ds_read_b64_tr_b16 v[66:67], v251 offset:33792
  v_mfma_f32_32x32x16_bf16 v[112:127], v[28:31], v[44:47], v[112:127]
  ds_read_b128 v[20:23], v246 offset:32768
  ds_read_b64_tr_b16 v[36:37], v249 offset:36864
  ds_read_b64_tr_b16 v[38:39], v249 offset:37888
  v_mfma_f32_32x32x16_bf16 v[128:143], v[28:31], v[60:63], v[128:143]
  ds_read_b64_tr_b16 v[52:53], v250 offset:36864
  ds_read_b64_tr_b16 v[54:55], v250 offset:37888
  v_mfma_f32_32x32x16_bf16 v[144:159], v[28:31], v[76:79], v[144:159]
  ds_read_b64_tr_b16 v[68:69], v251 offset:36864
  ds_read_b64_tr_b16 v[70:71], v251 offset:37888
  s_waitcnt lgkmcnt(11)
  v_mfma_f32_32x32x16_bf16 v[112:127], v[16:19], v[32:35], v[112:127]
  ds_read_b128 v[24:27], v247 offset:32768
  ds_read_b64_tr_b16 v[40:41], v249 offset:40960
  ds_read_b64_tr_b16 v[42:43], v249 offset:41984
  s_waitcnt lgkmcnt(12)
  v_mfma_f32_32x32x16_bf16 v[128:143], v[16:19], v[48:51], v[128:143]
  ds_read_b64_tr_b16 v[56:57], v250 offset:40960
  ds_read_b64_tr_b16 v[58:59], v250 offset:41984
  s_waitcnt lgkmcnt(12)
  v_mfma_f32_32x32x16_bf16 v[144:159], v[16:19], v[64:67], v[144:159]
  ds_read_b64_tr_b16 v[72:73], v251 offset:40960
  ds_read_b64_tr_b16 v[74:75], v251 offset:41984
  s_waitcnt lgkmcnt(11)
  v_mfma_f32_32x32x16_bf16 v[112:127], v[20:23], v[36:39], v[112:127]
  ds_read_b128 v[28:31], v248 offset:32768
  ds_read_b64_tr_b16 v[44:45], v249 offset:45056
  ds_read_b64_tr_b16 v[46:47], v249 offset:46080
  s_waitcnt lgkmcnt(12)
  v_mfma_f32_32x32x16_bf16 v[128:143], v[20:23], v[52:55], v[128:143]
  ds_read_b64_tr_b16 v[60:61], v250 offset:45056
  ds_read_b64_tr_b16 v[62:63], v250 offset:46080
  s_waitcnt lgkmcnt(12)
  v_mfma_f32_32x32x16_bf16 v[144:159], v[20:23], v[68:71], v[144:159]
  ds_read_b64_tr_b16 v[76:77], v251 offset:45056
  ds_read_b64_tr_b16 v[78:79], v251 offset:46080
  s_waitcnt lgkmcnt(11)
  v_mfma_f32_32x32x16_bf16 v[112:127], v[24:27], v[40:43], v[112:127]
  s_waitcnt lgkmcnt(9)
  v_mfma_f32_32x32x16_bf16 v[128:143], v[24:27], v[56:59], v[128:143]
  s_waitcnt lgkmcnt(7)
  v_mfma_f32_32x32x16_bf16 v[144:159], v[24:27], v[72:75], v[144:159]
  s_waitcnt lgkmcnt(0)
  s_barrier
  v_subrev_u32 v245, 32768, v245
  v_subrev_u32 v246, 32768, v246
  v_subrev_u32 v247, 32768, v247
  v_subrev_u32 v248, 32768, v248
  v_subrev_u32 v249, 32768, v249
  v_subrev_u32 v250, 32768, v250
  v_subrev_u32 v251, 32768, v251
  ds_read_b128 v[16:19], v245 offset:0
  ds_read_b64_tr_b16 v[32:33], v249 offset:0
  ds_read_b64_tr_b16 v[34:35], v249 offset:1024
  ds_read_b64_tr_b16 v[48:49], v250 offset:0
  ds_read_b64_tr_b16 v[50:51], v250 offset:1024
  ds_read_b64_tr_b16 v[64:65], v251 offset:0
  ds_read_b64_tr_b16 v[66:67], v251 offset:1024
  v_mfma_f32_32x32x16_bf16 v[112:127], v[28:31], v[44:47], v[112:127]
  ds_read_b128 v[20:23], v246 offset:0
  ds_read_b64_tr_b16 v[36:37], v249 offset:4096
  ds_read_b64_tr_b16 v[38:39], v249 offset:5120
  v_mfma_f32_32x32x16_bf16 v[128:143], v[28:31], v[60:63], v[128:143]
  ds_read_b64_tr_b16 v[52:53], v250 offset:4096
  ds_read_b64_tr_b16 v[54:55], v250 offset:5120
  v_mfma_f32_32x32x16_bf16 v[144:159], v[28:31], v[76:79], v[144:159]
  ds_read_b64_tr_b16 v[68:69], v251 offset:4096
  ds_read_b64_tr_b16 v[70:71], v251 offset:5120
  s_waitcnt lgkmcnt(11)
  v_mfma_f32_32x32x16_bf16 v[112:127], v[16:19], v[32:35], v[112:127]
  ds_read_b128 v[24:27], v247 offset:0
  ds_read_b64_tr_b16 v[40:41], v249 offset:8192
  ds_read_b64_tr_b16 v[42:43], v249 offset:9216
  s_waitcnt lgkmcnt(12)
  v_mfma_f32_32x32x16_bf16 v[128:143], v[16:19], v[48:51], v[128:143]
  ds_read_b64_tr_b16 v[56:57], v250 offset:8192
  ds_read_b64_tr_b16 v[58:59], v250 offset:9216
  s_waitcnt lgkmcnt(12)
  v_mfma_f32_32x32x16_bf16 v[144:159], v[16:19], v[64:67], v[144:159]
  ds_read_b64_tr_b16 v[72:73], v251 offset:8192
  ds_read_b64_tr_b16 v[74:75], v251 offset:9216
  s_waitcnt lgkmcnt(11)
  v_mfma_f32_32x32x16_bf16 v[112:127], v[20:23], v[36:39], v[112:127]
  ds_read_b128 v[28:31], v248 offset:0
  ds_read_b64_tr_b16 v[44:45], v249 offset:12288
  ds_read_b64_tr_b16 v[46:47], v249 offset:13312
  s_waitcnt lgkmcnt(12)
  v_mfma_f32_32x32x16_bf16 v[128:143], v[20:23], v[52:55], v[128:143]
  ds_read_b64_tr_b16 v[60:61], v250 offset:12288
  ds_read_b64_tr_b16 v[62:63], v250 offset:13312
  s_waitcnt lgkmcnt(12)
  v_mfma_f32_32x32x16_bf16 v[144:159], v[20:23], v[68:71], v[144:159]
  ds_read_b64_tr_b16 v[76:77], v251 offset:12288
  ds_read_b64_tr_b16 v[78:79], v251 offset:13312
  s_waitcnt lgkmcnt(11)
  v_mfma_f32_32x32x16_bf16 v[112:127], v[24:27], v[40:43], v[112:127]
  s_waitcnt lgkmcnt(9)
  v_mfma_f32_32x32x16_bf16 v[128:143], v[24:27], v[56:59], v[128:143]
  s_waitcnt lgkmcnt(7)
  v_mfma_f32_32x32x16_bf16 v[144:159], v[24:27], v[72:75], v[144:159]
  s_waitcnt lgkmcnt(0)
  s_barrier
  ds_read_b128 v[16:19], v245 offset:32768
  ds_read_b64_tr_b16 v[32:33], v249 offset:32768
  ds_read_b64_tr_b16 v[34:35], v249 offset:33792
  ds_read_b64_tr_b16 v[48:49], v250 offset:32768
  ds_read_b64_tr_b16 v[50:51], v250 offset:33792
  ds_read_b64_tr_b16 v[64:65], v251 offset:32768
  ds_read_b64_tr_b16 v[66:67], v251 offset:33792
  v_mfma_f32_32x32x16_bf16 v[112:127], v[28:31], v[44:47], v[112:127]
  ds_read_b128 v[20:23], v246 offset:32768
  ds_read_b64_tr_b16 v[36:37], v249 offset:36864
  ds_read_b64_tr_b16 v[38:39], v249 offset:37888
  v_mfma_f32_32x32x16_bf16 v[128:143], v[28:31], v[60:63], v[128:143]
  ds_read_b64_tr_b16 v[52:53], v250 offset:36864
  ds_read_b64_tr_b16 v[54:55], v250 offset:37888
  v_mfma_f32_32x32x16_bf16 v[144:159], v[28:31], v[76:79], v[144:159]
  ds_read_b64_tr_b16 v[68:69], v251 offset:36864
  ds_read_b64_tr_b16 v[70:71], v251 offset:37888
  s_waitcnt lgkmcnt(11)
  v_mfma_f32_32x32x16_bf16 v[112:127], v[16:19], v[32:35], v[112:127]
  ds_read_b128 v[24:27], v247 offset:32768
  ds_read_b64_tr_b16 v[40:41], v249 offset:40960
  ds_read_b64_tr_b16 v[42:43], v249 offset:41984
  s_waitcnt lgkmcnt(12)
  v_mfma_f32_32x32x16_bf16 v[128:143], v[16:19], v[48:51], v[128:143]
  ds_read_b64_tr_b16 v[56:57], v250 offset:40960
  ds_read_b64_tr_b16 v[58:59], v250 offset:41984
  s_waitcnt lgkmcnt(12)
  v_mfma_f32_32x32x16_bf16 v[144:159], v[16:19], v[64:67], v[144:159]
  ds_read_b64_tr_b16 v[72:73], v251 offset:40960
  ds_read_b64_tr_b16 v[74:75], v251 offset:41984
  s_waitcnt lgkmcnt(11)
  v_mfma_f32_32x32x16_bf16 v[112:127], v[20:23], v[36:39], v[112:127]
  ds_read_b128 v[28:31], v248 offset:32768
  ds_read_b64_tr_b16 v[44:45], v249 offset:45056
  ds_read_b64_tr_b16 v[46:47], v249 offset:46080
  s_waitcnt lgkmcnt(12)
  v_mfma_f32_32x32x16_bf16 v[128:143], v[20:23], v[52:55], v[128:143]
  ds_read_b64_tr_b16 v[60:61], v250 offset:45056
  ds_read_b64_tr_b16 v[62:63], v250 offset:46080
  s_waitcnt lgkmcnt(12)
  v_mfma_f32_32x32x16_bf16 v[144:159], v[20:23], v[68:71], v[144:159]
  ds_read_b64_tr_b16 v[76:77], v251 offset:45056
  ds_read_b64_tr_b16 v[78:79], v251 offset:46080
  s_waitcnt lgkmcnt(11)
  v_mfma_f32_32x32x16_bf16 v[112:127], v[24:27], v[40:43], v[112:127]
  s_waitcnt lgkmcnt(9)
  v_mfma_f32_32x32x16_bf16 v[128:143], v[24:27], v[56:59], v[128:143]
  s_waitcnt lgkmcnt(7)
  v_mfma_f32_32x32x16_bf16 v[144:159], v[24:27], v[72:75], v[144:159]
  s_waitcnt lgkmcnt(0)
  s_barrier
  v_add_u32 v245, 32768, v245
  v_add_u32 v246, 32768, v246
  v_add_u32 v247, 32768, v247
  v_add_u32 v248, 32768, v248
  v_add_u32 v249, 32768, v249
  v_add_u32 v250, 32768, v250
  v_add_u32 v251, 32768, v251
  ds_read_b128 v[16:19], v245 offset:32768
  ds_read_b64_tr_b16 v[32:33], v249 offset:32768
  ds_read_b64_tr_b16 v[34:35], v249 offset:33792
  ds_read_b64_tr_b16 v[48:49], v250 offset:32768
  ds_read_b64_tr_b16 v[50:51], v250 offset:33792
  ds_read_b64_tr_b16 v[64:65], v251 offset:32768
  ds_read_b64_tr_b16 v[66:67], v251 offset:33792
  v_mfma_f32_32x32x16_bf16 v[112:127], v[28:31], v[44:47], v[112:127]
  ds_read_b128 v[20:23], v246 offset:32768
  ds_read_b64_tr_b16 v[36:37], v249 offset:36864
  ds_read_b64_tr_b16 v[38:39], v249 offset:37888
  v_mfma_f32_32x32x16_bf16 v[128:143], v[28:31], v[60:63], v[128:143]
  ds_read_b64_tr_b16 v[52:53], v250 offset:36864
  ds_read_b64_tr_b16 v[54:55], v250 offset:37888
  v_mfma_f32_32x32x16_bf16 v[144:159], v[28:31], v[76:79], v[144:159]
  ds_read_b64_tr_b16 v[68:69], v251 offset:36864
  ds_read_b64_tr_b16 v[70:71], v251 offset:37888
  s_waitcnt lgkmcnt(11)
  v_mfma_f32_32x32x16_bf16 v[112:127], v[16:19], v[32:35], v[112:127]
  ds_read_b128 v[24:27], v247 offset:32768
  ds_read_b64_tr_b16 v[40:41], v249 offset:40960
  ds_read_b64_tr_b16 v[42:43], v249 offset:41984
  s_waitcnt lgkmcnt(12)
  v_mfma_f32_32x32x16_bf16 v[128:143], v[16:19], v[48:51], v[128:143]
  ds_read_b64_tr_b16 v[56:57], v250 offset:40960
  ds_read_b64_tr_b16 v[58:59], v250 offset:41984
  s_waitcnt lgkmcnt(12)
  v_mfma_f32_32x32x16_bf16 v[144:159], v[16:19], v[64:67], v[144:159]
  ds_read_b64_tr_b16 v[72:73], v251 offset:40960
  ds_read_b64_tr_b16 v[74:75], v251 offset:41984
  s_waitcnt lgkmcnt(11)
  v_mfma_f32_32x32x16_bf16 v[112:127], v[20:23], v[36:39], v[112:127]
  ds_read_b128 v[28:31], v248 offset:32768
  ds_read_b64_tr_b16 v[44:45], v249 offset:45056
  ds_read_b64_tr_b16 v[46:47], v249 offset:46080
  s_waitcnt lgkmcnt(12)
  v_mfma_f32_32x32x16_bf16 v[128:143], v[20:23], v[52:55], v[128:143]
  ds_read_b64_tr_b16 v[60:61], v250 offset:45056
  ds_read_b64_tr_b16 v[62:63], v250 offset:46080
  s_waitcnt lgkmcnt(12)
  v_mfma_f32_32x32x16_bf16 v[144:159], v[20:23], v[68:71], v[144:159]
  ds_read_b64_tr_b16 v[76:77], v251 offset:45056
  ds_read_b64_tr_b16 v[78:79], v251 offset:46080
  s_waitcnt lgkmcnt(11)
  v_mfma_f32_32x32x16_bf16 v[112:127], v[24:27], v[40:43], v[112:127]
  s_waitcnt lgkmcnt(9)
  v_mfma_f32_32x32x16_bf16 v[128:143], v[24:27], v[56:59], v[128:143]
  s_waitcnt lgkmcnt(7)
  v_mfma_f32_32x32x16_bf16 v[144:159], v[24:27], v[72:75], v[144:159]
  s_waitcnt lgkmcnt(4)
  v_mfma_f32_32x32x16_bf16 v[112:127], v[28:31], v[44:47], v[112:127]
  s_waitcnt lgkmcnt(2)
  v_mfma_f32_32x32x16_bf16 v[128:143], v[28:31], v[60:63], v[128:143]
  s_waitcnt lgkmcnt(0)
  v_mfma_f32_32x32x16_bf16 v[144:159], v[28:31], v[76:79], v[144:159]
  s_barrier
  v_subrev_u32 v245, 32768, v245
  v_subrev_u32 v246, 32768, v246
  v_subrev_u32 v247, 32768, v247
  v_subrev_u32 v248, 32768, v248
  v_subrev_u32 v249, 32768, v249
  v_subrev_u32 v250, 32768, v250
  v_subrev_u32 v251, 32768, v251
  ds_read_b128 v[16:19], v245 offset:0
  ds_read_b64_tr_b16 v[32:33], v249 offset:0
  ds_read_b64_tr_b16 v[34:35], v249 offset:1024
  ds_read_b128 v[20:23], v246 offset:0
  ds_read_b64_tr_b16 v[36:37], v249 offset:4096
  ds_read_b64_tr_b16 v[38:39], v249 offset:5120
  ds_read_b128 v[24:27], v247 offset:0
  ds_read_b64_tr_b16 v[40:41], v249 offset:8192
  ds_read_b64_tr_b16 v[42:43], v249 offset:9216
  ds_read_b128 v[28:31], v248 offset:0
  ds_read_b64_tr_b16 v[44:45], v249 offset:12288
  ds_read_b64_tr_b16 v[46:47], v249 offset:13312
  ds_read_b64_tr_b16 v[48:49], v250 offset:0
  ds_read_b64_tr_b16 v[50:51], v250 offset:1024
  ds_read_b64_tr_b16 v[52:53], v250 offset:4096
  ds_read_b64_tr_b16 v[54:55], v250 offset:5120
  ds_read_b64_tr_b16 v[56:57], v250 offset:8192
  ds_read_b64_tr_b16 v[58:59], v250 offset:9216
  ds_read_b64_tr_b16 v[60:61], v250 offset:12288
  ds_read_b64_tr_b16 v[62:63], v250 offset:13312
  ds_read_b64_tr_b16 v[64:65], v251 offset:0
  ds_read_b64_tr_b16 v[66:67], v251 offset:1024
  ds_read_b64_tr_b16 v[68:69], v251 offset:4096
  ds_read_b64_tr_b16 v[70:71], v251 offset:5120
  ds_read_b64_tr_b16 v[72:73], v251 offset:8192
  ds_read_b64_tr_b16 v[74:75], v251 offset:9216
  ds_read_b64_tr_b16 v[76:77], v251 offset:12288
  ds_read_b64_tr_b16 v[78:79], v251 offset:13312
  s_waitcnt lgkmcnt(15)
  v_mfma_f32_32x32x16_bf16 v[112:127], v[16:19], v[32:35], v[112:127]
  v_mfma_f32_32x32x16_bf16 v[112:127], v[20:23], v[36:39], v[112:127]
  v_mfma_f32_32x32x16_bf16 v[112:127], v[24:27], v[40:43], v[112:127]
  v_mfma_f32_32x32x16_bf16 v[112:127], v[28:31], v[44:47], v[112:127]
  s_waitcnt lgkmcnt(14)
  v_mfma_f32_32x32x16_bf16 v[128:143], v[16:19], v[48:51], v[128:143]
  s_waitcnt lgkmcnt(12)
  v_mfma_f32_32x32x16_bf16 v[128:143], v[20:23], v[52:55], v[128:143]
  s_waitcnt lgkmcnt(10)
  v_mfma_f32_32x32x16_bf16 v[128:143], v[24:27], v[56:59], v[128:143]
  s_mov_b32 s68, 0xf0000000
  s_mov_b32 s69, 0xf0000000
  s_nop 3
  v_cvt_pk_bf16_f32 v112, v112, v113
  v_cvt_pk_bf16_f32 v113, v114, v115
  v_cvt_pk_bf16_f32 v114, v116, v117
  v_cvt_pk_bf16_f32 v115, v118, v119
  s_waitcnt lgkmcnt(8)
  v_mfma_f32_32x32x16_bf16 v[128:143], v[28:31], v[60:63], v[128:143]
  v_cndmask_b32 v112, v112, v252, s[68:69]
  v_cndmask_b32 v113, v113, v252, s[68:69]
  v_cndmask_b32 v114, v114, v252, s[68:69]
  v_cndmask_b32 v115, v115, v252, s[68:69]
  buffer_store_dwordx4 v[112:115], v2, s[36:39], s11 offen offset:0 sc1
  s_waitcnt lgkmcnt(6)
  v_mfma_f32_32x32x16_bf16 v[144:159], v[16:19], v[64:67], v[144:159]
  v_cvt_pk_bf16_f32 v116, v120, v121
  v_cvt_pk_bf16_f32 v117, v122, v123
  v_cvt_pk_bf16_f32 v118, v124, v125
  v_cvt_pk_bf16_f32 v119, v126, v127
  v_cndmask_b32 v116, v116, v252, s[68:69]
  s_waitcnt lgkmcnt(4)
  v_mfma_f32_32x32x16_bf16 v[144:159], v[20:23], v[68:71], v[144:159]
  v_cndmask_b32 v117, v117, v252, s[68:69]
  v_cndmask_b32 v118, v118, v252, s[68:69]
  v_cndmask_b32 v119, v119, v252, s[68:69]
  buffer_store_dwordx4 v[116:119], v2, s[36:39], s11 offen offset:1024 sc1
  s_add_u32 s11, s11, 131072
  v_mov_b32 v11, 0x100
  s_waitcnt lgkmcnt(2)
  v_mfma_f32_32x32x16_bf16 v[144:159], v[24:27], v[72:75], v[144:159]
  v_cvt_pk_bf16_f32 v128, v128, v129
  v_cvt_pk_bf16_f32 v129, v130, v131
  s_waitcnt lgkmcnt(0)
  v_mfma_f32_32x32x16_bf16 v[144:159], v[28:31], v[76:79], v[144:159]
  v_cvt_pk_bf16_f32 v130, v132, v133
  v_cvt_pk_bf16_f32 v131, v134, v135
  s_mov_b64 exec, 1
  ds_add_u32 v10, v11
  s_mov_b64 exec, -1
  v_cndmask_b32 v128, v128, v252, s[68:69]
  v_cndmask_b32 v129, v129, v252, s[68:69]
  v_cndmask_b32 v130, v130, v252, s[68:69]
  v_cndmask_b32 v131, v131, v252, s[68:69]
  buffer_store_dwordx4 v[128:131], v2, s[36:39], s11 offen offset:0 sc1
  v_cvt_pk_bf16_f32 v132, v136, v137
  v_cvt_pk_bf16_f32 v133, v138, v139
  v_cvt_pk_bf16_f32 v134, v140, v141
  v_cvt_pk_bf16_f32 v135, v142, v143
  v_cndmask_b32 v132, v132, v252, s[68:69]
  v_cndmask_b32 v133, v133, v252, s[68:69]
  v_cndmask_b32 v134, v134, v252, s[68:69]
  v_cndmask_b32 v135, v135, v252, s[68:69]
  buffer_store_dwordx4 v[132:135], v2, s[36:39], s11 offen offset:1024 sc1
  s_add_u32 s11, s11, 131072
  v_cvt_pk_bf16_f32 v144, v144, v145
  v_cvt_pk_bf16_f32 v145, v146, v147
  v_cvt_pk_bf16_f32 v146, v148, v149
  v_cvt_pk_bf16_f32 v147, v150, v151
  v_cndmask_b32 v144, v144, v252, s[68:69]
  v_cndmask_b32 v145, v145, v252, s[68:69]
  v_cndmask_b32 v146, v146, v252, s[68:69]
  v_cndmask_b32 v147, v147, v252, s[68:69]
  buffer_store_dwordx4 v[144:147], v2, s[36:39], s11 offen offset:0 sc1
  v_cvt_pk_bf16_f32 v148, v152, v153
  v_cvt_pk_bf16_f32 v149, v154, v155
  v_cvt_pk_bf16_f32 v150, v156, v157
  v_cvt_pk_bf16_f32 v151, v158, v159
  v_cndmask_b32 v148, v148, v252, s[68:69]
  v_cndmask_b32 v149, v149, v252, s[68:69]
  v_cndmask_b32 v150, v150, v252, s[68:69]
  v_cndmask_b32 v151, v151, v252, s[68:69]
  buffer_store_dwordx4 v[148:151], v2, s[36:39], s11 offen offset:1024 sc1
EN_f5125:
EN_f5111:
  s_add_u32 m0, s61, 32768
  s_mul_i32 s64, s63, 229376
  buffer_load_dwordx4 v244, s[40:43], s64 offen lds
  s_add_u32 s64, s64, 27648
  buffer_load_dwordx4 v244, s[40:43], s64 offen offset:1024 lds
  s_add_u32 s63, s63, 1
  s_cmp_eq_u32 s63, 7
  s_cselect_b32 s63, 0, s63
  s_add_u32 m0, s61, 40960
  s_mul_i32 s64, s63, 229376
  buffer_load_dwordx4 v244, s[40:43], s64 offen lds
  s_add_u32 s64, s64, 27648
  buffer_load_dwordx4 v244, s[40:43], s64 offen offset:1024 lds
  s_add_u32 s63, s63, 1
  s_cmp_eq_u32 s63, 7
  s_cselect_b32 s63, 0, s63
  s_add_u32 m0, s61, 49152
  s_mul_i32 s64, s63, 229376
  buffer_load_dwordx4 v244, s[40:43], s64 offen lds
  s_add_u32 s64, s64, 27648
  buffer_load_dwordx4 v244, s[40:43], s64 offen offset:1024 lds
  s_add_u32 s63, s63, 1
  s_cmp_eq_u32 s63, 7
  s_cselect_b32 s63, 0, s63
  s_add_u32 m0, s61, 57344
  s_mul_i32 s64, s63, 229376
  buffer_load_dwordx4 v244, s[40:43], s64 offen lds
  s_add_u32 s64, s64, 27648
  buffer_load_dwordx4 v244, s[40:43], s64 offen offset:1024 lds
  s_add_u32 s63, s63, 1
  s_cmp_eq_u32 s63, 7
  s_cselect_b32 s63, 0, s63
  s_waitcnt vmcnt(8)
  v_mov_b32 v3, 155648
  v_mov_b32 v4, 1
  s_mov_b64 exec, 1
  ds_add_rtn_u32 v4, v3, v4 offset:8
  s_mov_b64 exec, -1
  s_waitcnt lgkmcnt(0)
  v_readfirstlane_b32 s46, v4
  s_nop 0
  s_cmp_eq_u32 s46, 3
  s_cbranch_scc0 EL_f5126
  s_mov_b64 exec, 0xff
  buffer_store_dwordx4 v[12:15], v2, s[36:39], s10 offen sc1
  s_mov_b64 exec, -1
EL_f5126:
  s_add_u32 m0, s61, 65536
  s_mul_i32 s64, s63, 229376
  buffer_load_dwordx4 v244, s[40:43], s64 offen lds
  s_add_u32 s64, s64, 27648
  buffer_load_dwordx4 v244, s[40:43], s64 offen offset:1024 lds
  s_add_u32 s63, s63, 1
  s_cmp_eq_u32 s63, 7
  s_cselect_b32 s63, 0, s63
  s_add_u32 m0, s61, 73728
  s_mul_i32 s64, s63, 229376
  buffer_load_dwordx4 v244, s[40:43], s64 offen lds
  s_add_u32 s64, s64, 27648
  buffer_load_dwordx4 v244, s[40:43], s64 offen offset:1024 lds
  s_add_u32 s63, s63, 1
  s_cmp_eq_u32 s63, 7
  s_cselect_b32 s63, 0, s63
  s_add_u32 m0, s61, 81920
  s_mul_i32 s64, s63, 229376
  buffer_load_dwordx4 v244, s[40:43], s64 offen lds
  s_add_u32 s64, s64, 27648
  buffer_load_dwordx4 v244, s[40:43], s64 offen offset:1024 lds
  s_add_u32 s63, s63, 1
  s_cmp_eq_u32 s63, 7
  s_cselect_b32 s63, 0, s63
  global_load_dword v0, v0, s[16:17]
  global_load_dword v255, v255, s[8:9]
  s_waitcnt vmcnt(8)
  v_mov_b32 v3, 155648
  v_mov_b32 v4, 1
  s_mov_b64 exec, 1
  ds_add_u32 v3, v4 offset:4
  s_mov_b64 exec, -1
  s_setprio 0
  v_bfe_u32 v4, v1, 4, 1
  v_and_b32 v3, 3, v1
  v_lshl_add_u32 v4, v4, 2, v3
  v_bfe_u32 v3, v1, 2, 2
  s_mul_i32 s3, s51, 28736
  v_lshl_add_u32 v248, v4, 3, s3
  v_lshrrev_b32 v5, 5, v1
  v_lshl_add_u32 v245, v5, 2, v3
  v_lshl_add_u32 v246, v5, 1, v3
  v_add_u32 v246, 16, v246
  v_lshl_add_u32 v247, v5, 2, 3
  v_cmp_gt_u32 vcc, 2, v3
  s_nop 1
  v_cndmask_b32 v246, v247, v246, vcc
  v_and_b32 v4, 2, v245
  v_lshlrev_b32 v4, 5, v4
  v_lshl_add_u32 v245, v245, 7, v248
  v_xor_b32 v245, v245, v4
  v_and_b32 v4, 2, v246
  v_lshlrev_b32 v4, 5, v4
  v_lshl_add_u32 v246, v246, 7, v248
  v_xor_b32 v246, v246, v4
  v_xor_b32 v247, 64, v245
  v_xor_b32 v248, 64, v246
  s_lshl_b32 s59, s71, 1
  s_add_u32 s59, s59, s51
  s_lshl_b32 s5, s65, 16
  s_mov_b32 s15, 0x04000c0c
  s_mul_i32 s73, s70, 14
  s_add_u32 s73, s73, s59
  s_lshl_b32 s73, s73, 12
  s_add_u32 s73, s73, 16777216
  v_and_b32 v3, 31, v1
  v_lshlrev_b32 v250, 2, v3
  v_mul_u32_u24 v251, 896, v3
  v_lshl_add_u32 v251, v5, 4, v251
  s_lshl_b32 s3, s59, 6
  v_add_u32 v251, s3, v251
  s_xor_b32 s3, s52, 2
  s_mul_i32 s3, s3, 12288
  s_add_u32 s3, s3, 106496
  v_add_u32 v252, s3, v2
  v_add_u32 v253, 4294918144, v8
  s_setprio 3
  s_waitcnt vmcnt(2)
  v_mov_b32 v3, 155648
  v_mov_b32 v4, 256
  s_mov_b64 exec, 1
  ds_add_u32 v3, v4 offset:4
  s_mov_b64 exec, -1
  s_cmp_eq_u32 s52, 0
  s_cbranch_scc0 EL_f5128
  s_mov_b32 s66, 65536
  s_mov_b64 exec, -1
LP_f5130:
  buffer_load_dword v9, v243, s[36:39], 0 offen offset:0 sc1
  s_sub_u32 s66, s66, 1
  s_waitcnt vmcnt(0)
  v_cmp_ne_u32 vcc, s65, v9
  s_nop 0
  s_cmp_lg_u64 vcc, 0
  s_cselect_b32 s3, s66, 0
  s_cmp_lg_u32 s3, 0
  s_cbranch_scc1 LP_f5130
  s_mov_b64 exec, -1
  v_mov_b32 v10, 155648
  v_mov_b32 v11, 256
  s_mov_b64 exec, 1
  ds_add_u32 v10, v11 offset:16
  s_mov_b64 exec, -1
  s_branch EN_f5129
EL_f5128:
  v_mov_b32 v10, 155648
  s_setprio 0
  s_mov_b32 s66, 1048576
LP_f5131:
  ds_read_b32 v11, v10 offset:16
  s_sub_u32 s66, s66, 1
  s_waitcnt lgkmcnt(0)
  v_readfirstlane_b32 s3, v11
  s_nop 0
  s_cmp_lt_u32 s3, 256
  s_cselect_b32 s3, s66, 0
  s_cmp_lg_u32 s3, 0
  s_cbranch_scc1 LP_f5131
  s_setprio 3
EN_f5129:
  buffer_load_dwordx4 v[48:51], v6, s[24:27], 0 offen offset:0 sc1
  buffer_load_dwordx4 v[52:55], v6, s[24:27], 0 offen offset:1024 sc1
  buffer_load_dwordx4 v[16:19], v2, s[36:39], s53 offen offset:0 sc1
  buffer_load_dwordx4 v[20:23], v2, s[36:39], s53 offen offset:1024 sc1
  buffer_load_dwordx4 v[24:27], v2, s[36:39], s55 offen offset:0 sc1
  buffer_load_dwordx4 v[28:31], v2, s[36:39], s55 offen offset:1024 sc1
  buffer_load_dwordx4 v[32:35], v2, s[36:39], s56 offen offset:0 sc1
  buffer_load_dwordx4 v[36:39], v2, s[36:39], s56 offen offset:1024 sc1
  buffer_load_dwordx4 v[80:83], v2, s[28:31], 0 offen offset:0 sc1
  buffer_load_dwordx4 v[84:87], v2, s[28:31], 0 offen offset:1024 sc1
  buffer_load_dwordx4 v[40:43], v2, s[36:39], s58 offen offset:0 sc1
  buffer_load_dwordx4 v[44:47], v2, s[36:39], s58 offen offset:1024 sc1
  buffer_load_dwordx4 v[56:59], v6, s[24:27], 0 offen offset:2048 sc1
  buffer_load_dwordx4 v[60:63], v6, s[24:27], 0 offen offset:3072 sc1
  buffer_load_dwordx4 v[88:91], v2, s[28:31], 0 offen offset:2048 sc1
  buffer_load_dwordx4 v[92:95], v2, s[28:31], 0 offen offset:3072 sc1
  v_mov_b32 v3, 155648
  v_mov_b32 v4, 65536
  s_mov_b64 exec, 1
  ds_add_u32 v3, v4 offset:4
  s_mov_b64 exec, -1
  s_setprio 1
  s_waitcnt vmcnt(13)
  v_mfma_f32_32x32x16_bf16 v[112:127], v[48:51], v[16:19], 0
  s_waitcnt vmcnt(12)
  v_mfma_f32_32x32x16_bf16 v[112:127], v[52:55], v[20:23], v[112:127]
  s_nop 11
  v_exp_f32 v112, v112
  v_exp_f32_e64 v113, v113
  v_exp_f32 v114, v114
  s_waitcnt vmcnt(11)
  v_mfma_f32_32x32x16_bf16 v[128:143], v[48:51], v[24:27], 0
  v_exp_f32 v115, v115
  buffer_load_dwordx4 v[64:67], v6, s[24:27], s12 offen offset:0 sc1
  v_exp_f32 v116, v116
  v_exp_f32_e64 v117, v117
  v_exp_f32 v118, v118
  s_waitcnt vmcnt(11)
  v_mfma_f32_32x32x16_bf16 v[128:143], v[52:55], v[28:31], v[128:143]
  v_exp_f32 v119, v119
  buffer_load_dwordx4 v[68:71], v6, s[24:27], s12 offen offset:1024 sc1
  v_exp_f32 v120, v120
  v_exp_f32_e64 v121, v121
  v_exp_f32 v122, v122
  s_waitcnt vmcnt(11)
  v_mfma_f32_32x32x16_bf16 v[144:159], v[48:51], v[32:35], 0
  v_exp_f32 v123, v123
  buffer_load_dwordx4 v[96:99], v2, s[28:31], s12 offen offset:0 sc1
  v_exp_f32 v124, v124
  v_exp_f32_e64 v125, v125
  v_exp_f32 v126, v126
  s_waitcnt vmcnt(11)
  v_mfma_f32_32x32x16_bf16 v[144:159], v[52:55], v[36:39], v[144:159]
  v_exp_f32 v127, v127
  buffer_load_dwordx4 v[100:103], v2, s[28:31], s12 offen offset:1024 sc1
  v_exp_f32 v128, v128
  v_exp_f32_e64 v129, v129
  s_waitcnt vmcnt(11)
  v_smfmac_f32_32x32x32_bf16 v[176:191], v[80:83], v[112:119], v7
  v_exp_f32 v130, v130
  v_exp_f32 v131, v131
  buffer_load_dwordx4 v[72:75], v6, s[24:27], s19 offen offset:0 sc1
  v_exp_f32 v132, v132
  s_waitcnt vmcnt(11)
  v_smfmac_f32_32x32x32_bf16 v[176:191], v[84:87], v[120:127], v7
  v_exp_f32_e64 v133, v133
  v_exp_f32 v134, v134
  v_exp_f32 v135, v135
  s_waitcnt vmcnt(10)
  v_mfma_f32_32x32x16_bf16 v[160:175], v[48:51], v[40:43], 0
  buffer_load_dwordx4 v[76:79], v6, s[24:27], s19 offen offset:1024 sc1
  v_exp_f32 v136, v136
  v_exp_f32_e64 v137, v137
  v_exp_f32 v138, v138
  s_waitcnt vmcnt(10)
  v_mfma_f32_32x32x16_bf16 v[160:175], v[52:55], v[44:47], v[160:175]
  v_exp_f32 v139, v139
  buffer_load_dwordx4 v[104:107], v2, s[28:31], s19 offen offset:0 sc1
  v_exp_f32 v140, v140
  v_exp_f32_e64 v141, v141
  v_smfmac_f32_32x32x32_bf16 v[192:207], v[80:83], v[128:135], v7
  v_exp_f32 v142, v142
  v_exp_f32 v143, v143
  buffer_load_dwordx4 v[108:111], v2, s[28:31], s19 offen offset:1024 sc1
  v_add_u32 v6, 2048, v6
  s_waitcnt vmcnt(8)
.p2align 6
LP_f5132:
  v_mfma_f32_32x32x16_bf16 v[112:127], v[56:59], v[16:19], 0
  buffer_load_dwordx4 v[48:51], v6, s[24:27], s19 offen offset:0 sc1
  v_exp_f32 v144, v144
  v_exp_f32 v145, v145
  v_exp_f32 v146, v146
  v_exp_f32 v147, v147
  v_mfma_f32_32x32x16_bf16 v[112:127], v[60:63], v[20:23], v[112:127]
  v_exp_f32 v148, v148
  v_exp_f32 v149, v149
  v_exp_f32 v150, v150
  v_exp_f32 v151, v151
  v_smfmac_f32_32x32x32_bf16 v[192:207], v[84:87], v[136:143], v7
  v_exp_f32 v152, v152
  v_exp_f32 v153, v153
  v_exp_f32 v154, v154
  v_exp_f32 v155, v155
  v_smfmac_f32_32x32x32_bf16 v[208:223], v[80:83], v[144:151], v7
  v_exp_f32 v156, v156
  v_exp_f32 v157, v157
  v_exp_f32 v158, v158
  v_exp_f32 v159, v159
  v_mfma_f32_32x32x16_bf16 v[128:143], v[56:59], v[24:27], 0
  buffer_load_dwordx4 v[52:55], v6, s[24:27], s19 offen offset:1024 sc1
  v_exp_f32 v160, v160
  v_exp_f32 v161, v161
  v_exp_f32 v162, v162
  v_exp_f32 v163, v163
  v_mfma_f32_32x32x16_bf16 v[128:143], v[60:63], v[28:31], v[128:143]
  v_exp_f32 v164, v164
  v_exp_f32 v165, v165
  v_exp_f32 v166, v166
  v_exp_f32 v167, v167
  v_smfmac_f32_32x32x32_bf16 v[208:223], v[84:87], v[152:159], v7
  v_exp_f32 v168, v168
  v_exp_f32 v169, v169
  v_exp_f32 v170, v170
  v_exp_f32 v171, v171
  v_smfmac_f32_32x32x32_bf16 v[224:239], v[80:83], v[160:167], v7
  v_exp_f32 v172, v172
  v_exp_f32 v173, v173
  v_exp_f32 v174, v174
  v_exp_f32 v175, v175
  v_mfma_f32_32x32x16_bf16 v[144:159], v[56:59], v[32:35], 0
  buffer_load_dwordx4 v[80:83], v2, s[28:31], s19 offen offset:2048 sc1
  v_exp_f32 v112, v112
  v_exp_f32 v113, v113
  v_exp_f32 v114, v114
  v_exp_f32 v115, v115
  v_mfma_f32_32x32x16_bf16 v[144:159], v[60:63], v[36:39], v[144:159]
  v_exp_f32 v116, v116
  v_exp_f32 v117, v117
  v_exp_f32 v118, v118
  v_exp_f32 v119, v119
  v_smfmac_f32_32x32x32_bf16 v[224:239], v[84:87], v[168:175], v7
  v_exp_f32 v120, v120
  v_exp_f32 v121, v121
  v_exp_f32 v122, v122
  v_exp_f32 v123, v123
  v_smfmac_f32_32x32x32_bf16 v[176:191], v[88:91], v[112:119], v7
  v_exp_f32 v124, v124
  v_exp_f32 v125, v125
  v_exp_f32 v126, v126
  v_exp_f32 v127, v127
  v_mfma_f32_32x32x16_bf16 v[160:175], v[56:59], v[40:43], 0
  buffer_load_dwordx4 v[84:87], v2, s[28:31], s19 offen offset:3072 sc1
  v_exp_f32 v128, v128
  v_exp_f32 v129, v129
  v_exp_f32 v130, v130
  v_exp_f32 v131, v131
  v_mfma_f32_32x32x16_bf16 v[160:175], v[60:63], v[44:47], v[160:175]
  s_waitcnt vmcnt(8)
  v_exp_f32 v132, v132
  v_exp_f32 v133, v133
  v_exp_f32 v134, v134
  v_exp_f32 v135, v135
  v_smfmac_f32_32x32x32_bf16 v[176:191], v[92:95], v[120:127], v7
  v_exp_f32 v136, v136
  v_exp_f32 v137, v137
  v_exp_f32 v138, v138
  v_exp_f32 v139, v139
  v_smfmac_f32_32x32x32_bf16 v[192:207], v[88:91], v[128:135], v7
  v_exp_f32 v140, v140
  v_exp_f32 v141, v141
  v_exp_f32 v142, v142
  v_exp_f32 v143, v143
  v_mfma_f32_32x32x16_bf16 v[112:127], v[64:67], v[16:19], 0
  buffer_load_dwordx4 v[56:59], v6, s[24:27], s19 offen offset:2048 sc1
  v_exp_f32 v144, v144
  v_exp_f32 v145, v145
  v_exp_f32 v146, v146
  v_exp_f32 v147, v147
  v_mfma_f32_32x32x16_bf16 v[112:127], v[68:71], v[20:23], v[112:127]
  v_exp_f32 v148, v148
  v_exp_f32 v149, v149
  v_exp_f32 v150, v150
  v_exp_f32 v151, v151
  v_smfmac_f32_32x32x32_bf16 v[192:207], v[92:95], v[136:143], v7
  v_exp_f32 v152, v152
  v_exp_f32 v153, v153
  v_exp_f32 v154, v154
  v_exp_f32 v155, v155
  v_smfmac_f32_32x32x32_bf16 v[208:223], v[88:91], v[144:151], v7
  v_exp_f32 v156, v156
  v_exp_f32 v157, v157
  v_exp_f32 v158, v158
  v_exp_f32 v159, v159
  v_mfma_f32_32x32x16_bf16 v[128:143], v[64:67], v[24:27], 0
  buffer_load_dwordx4 v[60:63], v6, s[24:27], s19 offen offset:3072 sc1
  v_exp_f32 v160, v160
  v_exp_f32 v161, v161
  v_exp_f32 v162, v162
  v_exp_f32 v163, v163
  v_mfma_f32_32x32x16_bf16 v[128:143], v[68:71], v[28:31], v[128:143]
  v_exp_f32 v164, v164
  v_exp_f32 v165, v165
  v_exp_f32 v166, v166
  v_exp_f32 v167, v167
  v_smfmac_f32_32x32x32_bf16 v[208:223], v[92:95], v[152:159], v7
  s_add_u32 s19, s19, 4096
  v_exp_f32 v168, v168
  v_exp_f32 v169, v169
  v_exp_f32 v170, v170
  v_exp_f32 v171, v171
  v_smfmac_f32_32x32x32_bf16 v[224:239], v[88:91], v[160:167], v7
  v_exp_f32 v172, v172
  v_exp_f32 v173, v173
  v_exp_f32 v174, v174
  v_exp_f32 v175, v175
  v_mfma_f32_32x32x16_bf16 v[144:159], v[64:67], v[32:35], 0
  buffer_load_dwordx4 v[88:91], v2, s[28:31], s19 offen offset:0 sc1
  v_exp_f32 v112, v112
  v_exp_f32 v113, v113
  v_exp_f32 v114, v114
  v_exp_f32 v115, v115
  v_mfma_f32_32x32x16_bf16 v[144:159], v[68:71], v[36:39], v[144:159]
  v_exp_f32 v116, v116
  v_exp_f32 v117, v117
  v_exp_f32 v118, v118
  v_exp_f32 v119, v119
  v_smfmac_f32_32x32x32_bf16 v[224:239], v[92:95], v[168:175], v7
  v_exp_f32 v120, v120
  v_exp_f32 v121, v121
  v_exp_f32 v122, v122
  v_exp_f32 v123, v123
  v_smfmac_f32_32x32x32_bf16 v[176:191], v[96:99], v[112:119], v7
  v_exp_f32 v124, v124
  v_exp_f32 v125, v125
  v_exp_f32 v126, v126
  v_exp_f32 v127, v127
  v_mfma_f32_32x32x16_bf16 v[160:175], v[64:67], v[40:43], 0
  buffer_load_dwordx4 v[92:95], v2, s[28:31], s19 offen offset:1024 sc1
  v_exp_f32 v128, v128
  v_exp_f32 v129, v129
  v_exp_f32 v130, v130
  v_exp_f32 v131, v131
  v_mfma_f32_32x32x16_bf16 v[160:175], v[68:71], v[44:47], v[160:175]
  s_waitcnt vmcnt(8)
  v_exp_f32 v132, v132
  v_exp_f32 v133, v133
  v_exp_f32 v134, v134
  v_exp_f32 v135, v135
  v_smfmac_f32_32x32x32_bf16 v[176:191], v[100:103], v[120:127], v7
  v_exp_f32 v136, v136
  v_exp_f32 v137, v137
  v_exp_f32 v138, v138
  v_exp_f32 v139, v139
  v_smfmac_f32_32x32x32_bf16 v[192:207], v[96:99], v[128:135], v7
  v_exp_f32 v140, v140
  v_exp_f32 v141, v141
  v_exp_f32 v142, v142
  v_exp_f32 v143, v143
  v_mfma_f32_32x32x16_bf16 v[112:127], v[72:75], v[16:19], 0
  buffer_load_dwordx4 v[64:67], v6, s[24:27], s19 offen offset:0 sc1
  v_exp_f32 v144, v144
  v_exp_f32 v145, v145
  v_exp_f32 v146, v146
  v_exp_f32 v147, v147
  v_mfma_f32_32x32x16_bf16 v[112:127], v[76:79], v[20:23], v[112:127]
  v_exp_f32 v148, v148
  v_exp_f32 v149, v149
  v_exp_f32 v150, v150
  v_exp_f32 v151, v151
  v_smfmac_f32_32x32x32_bf16 v[192:207], v[100:103], v[136:143], v7
  v_exp_f32 v152, v152
  v_exp_f32 v153, v153
  v_exp_f32 v154, v154
  v_exp_f32 v155, v155
  v_smfmac_f32_32x32x32_bf16 v[208:223], v[96:99], v[144:151], v7
  v_exp_f32 v156, v156
  v_exp_f32 v157, v157
  v_exp_f32 v158, v158
  v_exp_f32 v159, v159
  v_mfma_f32_32x32x16_bf16 v[128:143], v[72:75], v[24:27], 0
  buffer_load_dwordx4 v[68:71], v6, s[24:27], s19 offen offset:1024 sc1
  v_exp_f32 v160, v160
  v_exp_f32 v161, v161
  v_exp_f32 v162, v162
  v_exp_f32 v163, v163
  v_mfma_f32_32x32x16_bf16 v[128:143], v[76:79], v[28:31], v[128:143]
  v_exp_f32 v164, v164
  v_exp_f32 v165, v165
  v_exp_f32 v166, v166
  v_exp_f32 v167, v167
  v_smfmac_f32_32x32x32_bf16 v[208:223], v[100:103], v[152:159], v7
  v_exp_f32 v168, v168
  v_exp_f32 v169, v169
  v_exp_f32 v170, v170
  v_exp_f32 v171, v171
  v_smfmac_f32_32x32x32_bf16 v[224:239], v[96:99], v[160:167], v7
  v_exp_f32 v172, v172
  v_exp_f32 v173, v173
  v_exp_f32 v174, v174
  v_exp_f32 v175, v175
  v_mfma_f32_32x32x16_bf16 v[144:159], v[72:75], v[32:35], 0
  buffer_load_dwordx4 v[96:99], v2, s[28:31], s19 offen offset:2048 sc1
  v_exp_f32 v112, v112
  v_exp_f32 v113, v113
  v_exp_f32 v114, v114
  v_exp_f32 v115, v115
  v_mfma_f32_32x32x16_bf16 v[144:159], v[76:79], v[36:39], v[144:159]
  v_exp_f32 v116, v116
  v_exp_f32 v117, v117
  v_exp_f32 v118, v118
  v_exp_f32 v119, v119
  v_smfmac_f32_32x32x32_bf16 v[224:239], v[100:103], v[168:175], v7
  v_exp_f32 v120, v120
  v_exp_f32 v121, v121
  v_exp_f32 v122, v122
  v_exp_f32 v123, v123
  v_smfmac_f32_32x32x32_bf16 v[176:191], v[104:107], v[112:119], v7
  v_exp_f32 v124, v124
  v_exp_f32 v125, v125
  v_exp_f32 v126, v126
  v_exp_f32 v127, v127
  v_mfma_f32_32x32x16_bf16 v[160:175], v[72:75], v[40:43], 0
  buffer_load_dwordx4 v[100:103], v2, s[28:31], s19 offen offset:3072 sc1
  v_exp_f32 v128, v128
  v_exp_f32 v129, v129
  v_exp_f32 v130, v130
  v_exp_f32 v131, v131
  v_mfma_f32_32x32x16_bf16 v[160:175], v[76:79], v[44:47], v[160:175]
  s_waitcnt vmcnt(8)
  v_exp_f32 v132, v132
  v_exp_f32 v133, v133
  v_exp_f32 v134, v134
  v_exp_f32 v135, v135
  v_smfmac_f32_32x32x32_bf16 v[176:191], v[108:111], v[120:127], v7
  v_exp_f32 v136, v136
  v_exp_f32 v137, v137
  v_exp_f32 v138, v138
  v_exp_f32 v139, v139
  v_smfmac_f32_32x32x32_bf16 v[192:207], v[104:107], v[128:135], v7
  v_exp_f32 v140, v140
  v_exp_f32 v141, v141
  v_exp_f32 v142, v142
  v_exp_f32 v143, v143
  v_mfma_f32_32x32x16_bf16 v[112:127], v[48:51], v[16:19], 0
  buffer_load_dwordx4 v[72:75], v6, s[24:27], s19 offen offset:2048 sc1
  v_exp_f32 v144, v144
  v_exp_f32 v145, v145
  v_exp_f32 v146, v146
  v_exp_f32 v147, v147
  v_mfma_f32_32x32x16_bf16 v[112:127], v[52:55], v[20:23], v[112:127]
  v_exp_f32 v148, v148
  v_exp_f32 v149, v149
  v_exp_f32 v150, v150
  v_exp_f32 v151, v151
  v_smfmac_f32_32x32x32_bf16 v[192:207], v[108:111], v[136:143], v7
  v_exp_f32 v152, v152
  v_exp_f32 v153, v153
  v_exp_f32 v154, v154
  v_exp_f32 v155, v155
  v_smfmac_f32_32x32x32_bf16 v[208:223], v[104:107], v[144:151], v7
  v_exp_f32 v156, v156
  v_exp_f32 v157, v157
  v_exp_f32 v158, v158
  v_exp_f32 v159, v159
  v_mfma_f32_32x32x16_bf16 v[128:143], v[48:51], v[24:27], 0
  buffer_load_dwordx4 v[76:79], v6, s[24:27], s19 offen offset:3072 sc1
  v_exp_f32 v160, v160
  v_exp_f32 v161, v161
  v_exp_f32 v162, v162
  v_exp_f32 v163, v163
  v_mfma_f32_32x32x16_bf16 v[128:143], v[52:55], v[28:31], v[128:143]
  v_exp_f32 v164, v164
  v_exp_f32 v165, v165
  v_exp_f32 v166, v166
  v_exp_f32 v167, v167
  v_smfmac_f32_32x32x32_bf16 v[208:223], v[108:111], v[152:159], v7
  s_add_u32 s19, s19, 4096
  v_exp_f32 v168, v168
  v_exp_f32 v169, v169
  v_exp_f32 v170, v170
  v_exp_f32 v171, v171
  v_smfmac_f32_32x32x32_bf16 v[224:239], v[104:107], v[160:167], v7
  v_exp_f32 v172, v172
  v_exp_f32 v173, v173
  v_exp_f32 v174, v174
  v_exp_f32 v175, v175
  v_mfma_f32_32x32x16_bf16 v[144:159], v[48:51], v[32:35], 0
  buffer_load_dwordx4 v[104:107], v2, s[28:31], s19 offen offset:0 sc1
  v_exp_f32 v112, v112
  v_exp_f32 v113, v113
  v_exp_f32 v114, v114
  v_exp_f32 v115, v115
  v_mfma_f32_32x32x16_bf16 v[144:159], v[52:55], v[36:39], v[144:159]
  v_exp_f32 v116, v116
  v_exp_f32 v117, v117
  v_exp_f32 v118, v118
  v_exp_f32 v119, v119
  v_smfmac_f32_32x32x32_bf16 v[224:239], v[108:111], v[168:175], v7
  v_exp_f32 v120, v120
  v_exp_f32 v121, v121
  v_exp_f32 v122, v122
  v_exp_f32 v123, v123
  v_smfmac_f32_32x32x32_bf16 v[176:191], v[80:83], v[112:119], v7
  v_exp_f32 v124, v124
  v_exp_f32 v125, v125
  v_exp_f32 v126, v126
  v_exp_f32 v127, v127
  v_mfma_f32_32x32x16_bf16 v[160:175], v[48:51], v[40:43], 0
  buffer_load_dwordx4 v[108:111], v2, s[28:31], s19 offen offset:1024 sc1
  v_exp_f32 v128, v128
  v_exp_f32 v129, v129
  v_exp_f32 v130, v130
  v_exp_f32 v131, v131
  v_mfma_f32_32x32x16_bf16 v[160:175], v[52:55], v[44:47], v[160:175]
  s_waitcnt vmcnt(8)
  v_exp_f32 v132, v132
  v_exp_f32 v133, v133
  v_exp_f32 v134, v134
  v_exp_f32 v135, v135
  v_smfmac_f32_32x32x32_bf16 v[176:191], v[84:87], v[120:127], v7
  v_exp_f32 v136, v136
  v_exp_f32 v137, v137
  v_exp_f32 v138, v138
  v_exp_f32 v139, v139
  v_smfmac_f32_32x32x32_bf16 v[192:207], v[80:83], v[128:135], v7
  s_cmp_lt_u32 s19, 30720
  v_exp_f32 v140, v140
  v_exp_f32 v141, v141
  v_exp_f32 v142, v142
  v_exp_f32 v143, v143
  s_cbranch_scc1 LP_f5132
  v_mfma_f32_32x32x16_bf16 v[112:127], v[56:59], v[16:19], 0
  v_exp_f32 v144, v144
  v_exp_f32 v145, v145
  v_exp_f32 v146, v146
  v_exp_f32 v147, v147
  v_mfma_f32_32x32x16_bf16 v[112:127], v[60:63], v[20:23], v[112:127]
  v_exp_f32 v148, v148
  v_exp_f32 v149, v149
  v_exp_f32 v150, v150
  v_exp_f32 v151, v151
  v_smfmac_f32_32x32x32_bf16 v[192:207], v[84:87], v[136:143], v7
  v_exp_f32 v152, v152
  v_exp_f32 v153, v153
  v_exp_f32 v154, v154
  v_exp_f32 v155, v155
  v_smfmac_f32_32x32x32_bf16 v[208:223], v[80:83], v[144:151], v7
  v_exp_f32 v156, v156
  v_exp_f32 v157, v157
  v_exp_f32 v158, v158
  v_exp_f32 v159, v159
  v_mfma_f32_32x32x16_bf16 v[128:143], v[56:59], v[24:27], 0
  v_exp_f32 v160, v160
  v_exp_f32 v161, v161
  v_exp_f32 v162, v162
  v_exp_f32 v163, v163
  v_mfma_f32_32x32x16_bf16 v[128:143], v[60:63], v[28:31], v[128:143]
  v_exp_f32 v164, v164
  v_exp_f32 v165, v165
  v_exp_f32 v166, v166
  v_exp_f32 v167, v167
  v_smfmac_f32_32x32x32_bf16 v[208:223], v[84:87], v[152:159], v7
  v_exp_f32 v168, v168
  v_exp_f32 v169, v169
  v_exp_f32 v170, v170
  v_exp_f32 v171, v171
  v_smfmac_f32_32x32x32_bf16 v[224:239], v[80:83], v[160:167], v7
  v_exp_f32 v172, v172
  v_exp_f32 v173, v173
  v_exp_f32 v174, v174
  v_exp_f32 v175, v175
  v_mfma_f32_32x32x16_bf16 v[144:159], v[56:59], v[32:35], 0
  v_exp_f32 v112, v112
  v_exp_f32 v113, v113
  v_exp_f32 v114, v114
  v_exp_f32 v115, v115
  v_mfma_f32_32x32x16_bf16 v[144:159], v[60:63], v[36:39], v[144:159]
  v_exp_f32 v116, v116
  v_exp_f32 v117, v117
  v_exp_f32 v118, v118
  v_exp_f32 v119, v119
  v_smfmac_f32_32x32x32_bf16 v[224:239], v[84:87], v[168:175], v7
  v_exp_f32 v120, v120
  v_exp_f32 v121, v121
  v_exp_f32 v122, v122
  v_exp_f32 v123, v123
  v_smfmac_f32_32x32x32_bf16 v[176:191], v[88:91], v[112:119], v7
  v_exp_f32 v124, v124
  v_exp_f32 v125, v125
  v_exp_f32 v126, v126
  v_exp_f32 v127, v127
  v_mfma_f32_32x32x16_bf16 v[160:175], v[56:59], v[40:43], 0
  v_exp_f32 v128, v128
  v_exp_f32 v129, v129
  v_exp_f32 v130, v130
  v_exp_f32 v131, v131
  v_mfma_f32_32x32x16_bf16 v[160:175], v[60:63], v[44:47], v[160:175]
  s_waitcnt vmcnt(4)
  v_exp_f32 v132, v132
  v_exp_f32 v133, v133
  v_exp_f32 v134, v134
  v_exp_f32 v135, v135
  v_smfmac_f32_32x32x32_bf16 v[176:191], v[92:95], v[120:127], v7
  v_exp_f32 v136, v136
  v_exp_f32 v137, v137
  v_exp_f32 v138, v138
  v_exp_f32 v139, v139
  v_smfmac_f32_32x32x32_bf16 v[192:207], v[88:91], v[128:135], v7
  v_exp_f32 v140, v140
  v_exp_f32 v141, v141
  v_exp_f32 v142, v142
  v_exp_f32 v143, v143
  v_mfma_f32_32x32x16_bf16 v[112:127], v[64:67], v[16:19], 0
  v_exp_f32 v144, v144
  v_exp_f32 v145, v145
  v_exp_f32 v146, v146
  v_exp_f32 v147, v147
  v_mfma_f32_32x32x16_bf16 v[112:127], v[68:71], v[20:23], v[112:127]
  v_exp_f32 v148, v148
  v_exp_f32 v149, v149
  v_exp_f32 v150, v150
  v_exp_f32 v151, v151
  v_smfmac_f32_32x32x32_bf16 v[192:207], v[92:95], v[136:143], v7
  v_exp_f32 v152, v152
  v_exp_f32 v153, v153
  v_exp_f32 v154, v154
  v_exp_f32 v155, v155
  v_smfmac_f32_32x32x32_bf16 v[208:223], v[88:91], v[144:151], v7
  v_exp_f32 v156, v156
  v_exp_f32 v157, v157
  v_exp_f32 v158, v158
  v_exp_f32 v159, v159
  v_mfma_f32_32x32x16_bf16 v[128:143], v[64:67], v[24:27], 0
  v_exp_f32 v160, v160
  v_exp_f32 v161, v161
  v_exp_f32 v162, v162
  v_exp_f32 v163, v163
  v_mfma_f32_32x32x16_bf16 v[128:143], v[68:71], v[28:31], v[128:143]
  v_exp_f32 v164, v164
  v_exp_f32 v165, v165
  v_exp_f32 v166, v166
  v_exp_f32 v167, v167
  v_smfmac_f32_32x32x32_bf16 v[208:223], v[92:95], v[152:159], v7
  v_exp_f32 v168, v168
  v_exp_f32 v169, v169
  v_exp_f32 v170, v170
  v_exp_f32 v171, v171
  v_smfmac_f32_32x32x32_bf16 v[224:239], v[88:91], v[160:167], v7
  v_exp_f32 v172, v172
  v_exp_f32 v173, v173
  v_exp_f32 v174, v174
  v_exp_f32 v175, v175
  v_mfma_f32_32x32x16_bf16 v[144:159], v[64:67], v[32:35], 0
  v_exp_f32 v112, v112
  v_exp_f32 v113, v113
  v_exp_f32 v114, v114
  v_exp_f32 v115, v115
  v_mfma_f32_32x32x16_bf16 v[144:159], v[68:71], v[36:39], v[144:159]
  v_exp_f32 v116, v116
  v_exp_f32 v117, v117
  v_exp_f32 v118, v118
  v_exp_f32 v119, v119
  v_smfmac_f32_32x32x32_bf16 v[224:239], v[92:95], v[168:175], v7
  v_exp_f32 v120, v120
  v_exp_f32 v121, v121
  v_exp_f32 v122, v122
  v_exp_f32 v123, v123
  v_smfmac_f32_32x32x32_bf16 v[176:191], v[96:99], v[112:119], v7
  v_exp_f32 v124, v124
  v_exp_f32 v125, v125
  v_exp_f32 v126, v126
  v_exp_f32 v127, v127
  v_mfma_f32_32x32x16_bf16 v[160:175], v[64:67], v[40:43], 0
  v_exp_f32 v128, v128
  v_exp_f32 v129, v129
  v_exp_f32 v130, v130
  v_exp_f32 v131, v131
  v_mfma_f32_32x32x16_bf16 v[160:175], v[68:71], v[44:47], v[160:175]
  s_waitcnt vmcnt(0)
  v_exp_f32 v132, v132
  v_exp_f32 v133, v133
  v_exp_f32 v134, v134
  v_exp_f32 v135, v135
  v_smfmac_f32_32x32x32_bf16 v[176:191], v[100:103], v[120:127], v7
  v_exp_f32 v136, v136
  v_exp_f32 v137, v137
  v_exp_f32 v138, v138
  v_exp_f32 v139, v139
  v_smfmac_f32_32x32x32_bf16 v[192:207], v[96:99], v[128:135], v7
  v_exp_f32 v140, v140
  v_exp_f32 v141, v141
  v_exp_f32 v142, v142
  v_exp_f32 v143, v143
  v_mfma_f32_32x32x16_bf16 v[112:127], v[72:75], v[16:19], 0
  v_exp_f32 v144, v144
  v_exp_f32 v145, v145
  v_exp_f32 v146, v146
  v_exp_f32 v147, v147
  v_mfma_f32_32x32x16_bf16 v[112:127], v[76:79], v[20:23], v[112:127]
  v_exp_f32 v148, v148
  v_exp_f32 v149, v149
  v_exp_f32 v150, v150
  v_exp_f32 v151, v151
  v_smfmac_f32_32x32x32_bf16 v[192:207], v[100:103], v[136:143], v7
  v_exp_f32 v152, v152
  v_exp_f32 v153, v153
  v_exp_f32 v154, v154
  v_exp_f32 v155, v155
  v_smfmac_f32_32x32x32_bf16 v[208:223], v[96:99], v[144:151], v7
  v_exp_f32 v156, v156
  v_exp_f32 v157, v157
  v_exp_f32 v158, v158
  v_exp_f32 v159, v159
  v_mfma_f32_32x32x16_bf16 v[128:143], v[72:75], v[24:27], 0
  v_exp_f32 v160, v160
  v_exp_f32 v161, v161
  v_exp_f32 v162, v162
  v_exp_f32 v163, v163
  v_mfma_f32_32x32x16_bf16 v[128:143], v[76:79], v[28:31], v[128:143]
  v_exp_f32 v164, v164
  v_exp_f32 v165, v165
  v_exp_f32 v166, v166
  v_exp_f32 v167, v167
  v_smfmac_f32_32x32x32_bf16 v[208:223], v[100:103], v[152:159], v7
  v_exp_f32 v168, v168
  v_exp_f32 v169, v169
  v_exp_f32 v170, v170
  v_exp_f32 v171, v171
  v_smfmac_f32_32x32x32_bf16 v[224:239], v[96:99], v[160:167], v7
  v_exp_f32 v172, v172
  v_exp_f32 v173, v173
  v_exp_f32 v174, v174
  v_exp_f32 v175, v175
  v_mfma_f32_32x32x16_bf16 v[144:159], v[72:75], v[32:35], 0
  v_exp_f32 v112, v112
  v_exp_f32 v113, v113
  v_exp_f32 v114, v114
  v_exp_f32 v115, v115
  v_mfma_f32_32x32x16_bf16 v[144:159], v[76:79], v[36:39], v[144:159]
  v_exp_f32 v116, v116
  v_exp_f32 v117, v117
  v_exp_f32 v118, v118
  v_exp_f32 v119, v119
  v_smfmac_f32_32x32x32_bf16 v[224:239], v[100:103], v[168:175], v7
  v_exp_f32 v120, v120
  v_exp_f32 v121, v121
  v_exp_f32 v122, v122
  v_exp_f32 v123, v123
  v_smfmac_f32_32x32x32_bf16 v[176:191], v[104:107], v[112:119], v7
  v_exp_f32 v124, v124
  v_exp_f32 v125, v125
  v_exp_f32 v126, v126
  v_exp_f32 v127, v127
  v_mfma_f32_32x32x16_bf16 v[160:175], v[72:75], v[40:43], 0
  v_exp_f32 v128, v128
  v_exp_f32 v129, v129
  v_exp_f32 v130, v130
  v_exp_f32 v131, v131
  v_mfma_f32_32x32x16_bf16 v[160:175], v[76:79], v[44:47], v[160:175]
  v_exp_f32 v132, v132
  v_exp_f32 v133, v133
  v_exp_f32 v134, v134
  v_exp_f32 v135, v135
  v_smfmac_f32_32x32x32_bf16 v[176:191], v[108:111], v[120:127], v7
  v_exp_f32 v136, v136
  v_exp_f32 v137, v137
  v_exp_f32 v138, v138
  v_exp_f32 v139, v139
  v_smfmac_f32_32x32x32_bf16 v[192:207], v[104:107], v[128:135], v7
  v_exp_f32 v140, v140
  v_exp_f32 v141, v141
  v_exp_f32 v142, v142
  v_exp_f32 v143, v143
  s_setprio 3
  s_barrier
  v_exp_f32 v144, v144
  v_exp_f32 v145, v145
  v_exp_f32 v146, v146
  v_exp_f32 v147, v147
  v_smfmac_f32_32x32x32_bf16 v[192:207], v[108:111], v[136:143], v7
  v_exp_f32 v148, v148
  ds_write_b128 v240, v[176:179] offset:0
  v_exp_f32 v149, v149
  ds_write_b128 v240, v[180:183] offset:1024
  v_exp_f32 v150, v150
  ds_write_b128 v240, v[184:187] offset:2048
  v_exp_f32 v151, v151
  ds_write_b128 v240, v[188:191] offset:3072
  v_exp_f32 v152, v152
  v_exp_f32 v153, v153
  v_exp_f32 v154, v154
  v_exp_f32 v155, v155
  v_smfmac_f32_32x32x32_bf16 v[208:223], v[104:107], v[144:151], v7
  v_exp_f32 v156, v156
  v_exp_f32 v157, v157
  v_exp_f32 v158, v158
  v_exp_f32 v159, v159
  v_exp_f32 v160, v160
  v_exp_f32 v161, v161
  v_exp_f32 v162, v162
  v_exp_f32 v163, v163
  v_smfmac_f32_32x32x32_bf16 v[208:223], v[108:111], v[152:159], v7
  v_exp_f32 v164, v164
  ds_write_b128 v241, v[192:195] offset:0
  v_exp_f32 v165, v165
  ds_write_b128 v241, v[196:199] offset:1024
  v_exp_f32 v166, v166
  ds_write_b128 v241, v[200:203] offset:2048
  v_exp_f32 v167, v167
  ds_write_b128 v241, v[204:207] offset:3072
  s_nop 0
  v_smfmac_f32_32x32x32_bf16 v[224:239], v[104:107], v[160:167], v7
  v_exp_f32 v168, v168
  v_exp_f32 v169, v169
  ds_write_b128 v242, v[208:211] offset:0
  v_exp_f32 v170, v170
  v_exp_f32 v171, v171
  ds_write_b128 v242, v[212:215] offset:1024
  v_exp_f32 v172, v172
  v_exp_f32 v173, v173
  ds_write_b128 v242, v[216:219] offset:2048
  v_exp_f32 v174, v174
  v_exp_f32 v175, v175
  ds_write_b128 v242, v[220:223] offset:3072
  s_nop 0
  v_smfmac_f32_32x32x32_bf16 v[224:239], v[108:111], v[168:175], v7
  s_setprio 0
  s_waitcnt lgkmcnt(0)
  v_mov_b32 v10, 155648
  v_mov_b32 v11, 1
  s_mov_b64 exec, 1
  ds_add_u32 v10, v11 offset:16
  s_mov_b64 exec, -1
  v_mov_b32 v10, 155648
  s_mov_b32 s66, 1048576
LP_f5133:
  ds_read_b32 v11, v10 offset:16
  s_sub_u32 s66, s66, 1
  s_waitcnt lgkmcnt(0)
  v_readfirstlane_b32 s3, v11
  s_nop 0
  s_cmp_lt_u32 s3, 260
  s_cselect_b32 s3, s66, 0
  s_cmp_lg_u32 s3, 0
  s_cbranch_scc1 LP_f5133
  ds_read_b128 v[176:179], v8 offset:0
  ds_read_b128 v[180:183], v8 offset:1024
  ds_read_b128 v[184:187], v8 offset:2048
  ds_read_b128 v[188:191], v8 offset:3072
  ds_read_b128 v[192:195], v8 offset:4096
  ds_read_b128 v[196:199], v8 offset:5120
  ds_read_b128 v[200:203], v8 offset:6144
  ds_read_b128 v[204:207], v8 offset:7168
  ds_read_b128 v[208:211], v8 offset:8192
  ds_read_b128 v[212:215], v8 offset:9216
  ds_read_b128 v[216:219], v8 offset:10240
  ds_read_b128 v[220:223], v8 offset:11264
  s_waitcnt lgkmcnt(11)
  v_add_f32 v224, v224, v176
  v_add_f32 v225, v225, v177
  v_add_f32 v226, v226, v178
  v_add_f32 v227, v227, v179
  s_waitcnt lgkmcnt(10)
  v_add_f32 v228, v228, v180
  v_add_f32 v229, v229, v181
  v_add_f32 v230, v230, v182
  v_add_f32 v231, v231, v183
  s_waitcnt lgkmcnt(9)
  v_add_f32 v232, v232, v184
  v_add_f32 v233, v233, v185
  v_add_f32 v234, v234, v186
  v_add_f32 v235, v235, v187
  s_waitcnt lgkmcnt(8)
  v_add_f32 v236, v236, v188
  v_add_f32 v237, v237, v189
  v_add_f32 v238, v238, v190
  v_add_f32 v239, v239, v191
  s_waitcnt lgkmcnt(7)
  v_add_f32 v224, v224, v192
  v_add_f32 v225, v225, v193
  v_add_f32 v226, v226, v194
  v_add_f32 v227, v227, v195
  s_waitcnt lgkmcnt(6)
  v_add_f32 v228, v228, v196
  v_add_f32 v229, v229, v197
  v_add_f32 v230, v230, v198
  v_add_f32 v231, v231, v199
  s_waitcnt lgkmcnt(5)
  v_add_f32 v232, v232, v200
  v_add_f32 v233, v233, v201
  v_add_f32 v234, v234, v202
  v_add_f32 v235, v235, v203
  s_waitcnt lgkmcnt(4)
  v_add_f32 v236, v236, v204
  v_add_f32 v237, v237, v205
  v_add_f32 v238, v238, v206
  v_add_f32 v239, v239, v207
  s_waitcnt lgkmcnt(3)
  v_add_f32 v224, v224, v208
  v_add_f32 v225, v225, v209
  v_add_f32 v226, v226, v210
  v_add_f32 v227, v227, v211
  s_waitcnt lgkmcnt(2)
  v_add_f32 v228, v228, v212
  v_add_f32 v229, v229, v213
  v_add_f32 v230, v230, v214
  v_add_f32 v231, v231, v215
  s_waitcnt lgkmcnt(1)
  v_add_f32 v232, v232, v216
  v_add_f32 v233, v233, v217
  v_add_f32 v234, v234, v218
  v_add_f32 v235, v235, v219
  s_waitcnt lgkmcnt(0)
  v_add_f32 v236, v236, v220
  v_add_f32 v237, v237, v221
  v_add_f32 v238, v238, v222
  v_add_f32 v239, v239, v223
  v_mov_b32 v3, v236
  v_mov_b32 v4, v236
  s_nop 1
  v_permlane32_swap_b32 v3, v4
  v_mul_f32 v10, v224, v225
  v_mul_f32 v11, v226, v227
  v_fma_f32 v10, v228, v229, v10
  v_fma_f32 v11, v230, v231, v11
  v_fma_f32 v10, v232, v233, v10
  v_fma_f32 v11, v234, v235, v11
  v_fma_f32 v10, v236, v237, v10
  v_fma_f32 v11, v238, v239, v11
  v_fma_f32 v5, v10, 0, v4
  v_fma_f32 v5, v11, 0, v5
  v_cmp_nlt_f32 vcc, 0x30800000, v5
  s_nop 0
  s_mov_b64 s[68:69], vcc
  v_cmp_ngt_f32 vcc, 0x53800000, v5
  s_nop 0
  s_or_b64 s[68:69], s[68:69], vcc
  s_cmp_lg_u64 s[68:69], 0
  s_cbranch_scc0 EL_f5134
  s_lshl_b32 s60, s44, 17
  s_add_u32 s3, s60, 3145728
  s_add_u32 s24, s20, s3
  s_addc_u32 s25, s21, 0
  s_mov_b32 s26, 131072
  s_mov_b32 s27, 0x20000
  s_add_u32 s3, s60, 5242880
  s_add_u32 s28, s20, s3
  s_addc_u32 s29, s21, 0
  s_mov_b32 s30, 131072
  s_mov_b32 s31, 0x20000
  v_subrev_u32 v6, 2048, v6
  v_mov_b32 v3, 0xff800000
  s_mov_b32 s19, 0
LP_f5136:
  buffer_load_dwordx4 v[144:147], v6, s[24:27], s19 offen offset:0 sc1
  buffer_load_dwordx4 v[148:151], v6, s[24:27], s19 offen offset:1024 sc1
  s_waitcnt vmcnt(1)
  v_mfma_f32_32x32x16_bf16 v[160:175], v[144:147], v[40:43], 0
  s_waitcnt vmcnt(0)
  v_mfma_f32_32x32x16_bf16 v[160:175], v[148:151], v[44:47], v[160:175]
  s_nop 11
  v_max3_f32 v3, v160, v161, v3
  v_max3_f32 v3, v162, v163, v3
  v_max3_f32 v3, v164, v165, v3
  v_max3_f32 v3, v166, v167, v3
  v_max3_f32 v3, v168, v169, v3
  v_max3_f32 v3, v170, v171, v3
  v_max3_f32 v3, v172, v173, v3
  v_max3_f32 v3, v174, v175, v3
  s_add_u32 s19, s19, 2048
  s_cmp_lt_u32 s19, 131072
  s_cbranch_scc1 LP_f5136
  v_mov_b32 v4, v3
  s_nop 1
  v_permlane32_swap_b32 v3, v4
  v_max_f32 v3, v3, v4
  v_mul_f32 v176, -1.0, v3
  v_mov_b32 v224, 0
  v_mul_f32 v177, -1.0, v3
  v_mov_b32 v225, 0
  v_mul_f32 v178, -1.0, v3
  v_mov_b32 v226, 0
  v_mul_f32 v179, -1.0, v3
  v_mov_b32 v227, 0
  v_mul_f32 v180, -1.0, v3
  v_mov_b32 v228, 0
  v_mul_f32 v181, -1.0, v3
  v_mov_b32 v229, 0
  v_mul_f32 v182, -1.0, v3
  v_mov_b32 v230, 0
  v_mul_f32 v183, -1.0, v3
  v_mov_b32 v231, 0
  v_mul_f32 v184, -1.0, v3
  v_mov_b32 v232, 0
  v_mul_f32 v185, -1.0, v3
  v_mov_b32 v233, 0
  v_mul_f32 v186, -1.0, v3
  v_mov_b32 v234, 0
  v_mul_f32 v187, -1.0, v3
  v_mov_b32 v235, 0
  v_mul_f32 v188, -1.0, v3
  v_mov_b32 v236, 0
  v_mul_f32 v189, -1.0, v3
  v_mov_b32 v237, 0
  v_mul_f32 v190, -1.0, v3
  v_mov_b32 v238, 0
  v_mul_f32 v191, -1.0, v3
  v_mov_b32 v239, 0
  s_mov_b32 s19, 0
LP_f5137:
  buffer_load_dwordx4 v[144:147], v6, s[24:27], s19 offen offset:0 sc1
  buffer_load_dwordx4 v[148:151], v6, s[24:27], s19 offen offset:1024 sc1
  buffer_load_dwordx4 v[152:155], v2, s[28:31], s19 offen offset:0 sc1
  buffer_load_dwordx4 v[156:159], v2, s[28:31], s19 offen offset:1024 sc1
  s_waitcnt vmcnt(3)
  v_mfma_f32_32x32x16_bf16 v[160:175], v[144:147], v[40:43], v[176:191]
  s_waitcnt vmcnt(2)
  v_mfma_f32_32x32x16_bf16 v[160:175], v[148:151], v[44:47], v[160:175]
  s_nop 11
  v_exp_f32 v160, v160
  v_exp_f32 v161, v161
  v_exp_f32 v162, v162
  v_exp_f32 v163, v163
  v_exp_f32 v164, v164
  v_exp_f32 v165, v165
  v_exp_f32 v166, v166
  v_exp_f32 v167, v167
  v_exp_f32 v168, v168
  v_exp_f32 v169, v169
  v_exp_f32 v170, v170
  v_exp_f32 v171, v171
  v_exp_f32 v172, v172
  v_exp_f32 v173, v173
  v_exp_f32 v174, v174
  v_exp_f32 v175, v175
  s_waitcnt vmcnt(1)
  v_smfmac_f32_32x32x32_bf16 v[224:239], v[152:155], v[160:167], v7
  s_waitcnt vmcnt(0)
  v_smfmac_f32_32x32x32_bf16 v[224:239], v[156:159], v[168:175], v7
  s_add_u32 s19, s19, 2048
  s_cmp_lt_u32 s19, 131072
  s_nop 4
  s_cbranch_scc1 LP_f5137
  s_nop 3
  v_mov_b32 v3, v236
  v_mov_b32 v4, v236
  s_nop 1
  v_permlane32_swap_b32 v3, v4
EL_f5134:
  v_rcp_f32 v4, v4
  s_nop 0
  v_mul_f32 v224, v224, v4
  v_mul_f32 v225, v225, v4
  v_mul_f32 v226, v226, v4
  v_mul_f32 v227, v227, v4
  v_mul_f32 v228, v228, v4
  v_mul_f32 v229, v229, v4
  v_mul_f32 v230, v230, v4
  v_mul_f32 v231, v231, v4
  v_cvt_pk_bf16_f32 v3, v230, v231
  v_cvt_pk_bf16_f32 v5, v231, v230
  v_cvt_pk_bf16_f32 v224, v224, v225
  v_cvt_pk_bf16_f32 v225, v226, v227
  v_cvt_pk_bf16_f32 v226, v228, v229
  v_alignbit_b32 v227, v12, v5, 16
  buffer_store_dwordx4 v[224:227], v2, s[36:39], s47 offen offset:0 sc1
  v_mul_f32 v232, v232, v4
  v_mul_f32 v233, v233, v4
  v_mul_f32 v234, v234, v4
  v_mul_f32 v235, v235, v4
  v_mul_f32 v236, v236, v4
  v_mul_f32 v237, v237, v4
  v_mul_f32 v238, v238, v4
  v_mul_f32 v239, v239, v4
  v_cvt_pk_bf16_f32 v230, v236, v237
  v_cvt_pk_bf16_f32 v231, v238, v239
  v_cvt_pk_bf16_f32 v228, v232, v233
  v_cvt_pk_bf16_f32 v229, v234, v235
  v_permlane32_swap_b32 v230, v231
  v_alignbit_b32 v231, v12, v3, 16
  buffer_store_dwordx4 v[228:231], v2, s[36:39], s47 offen offset:1024 sc1
  s_cmp_ge_u32 s2, 224
  s_cbranch_scc0 EL_f5138
  s_endpgm
EL_f5138:
  s_setprio 0
  ds_read_b64_tr_b16 v[48:49], v245 offset:0
  ds_read_b64_tr_b16 v[50:51], v245 offset:1024
  ds_read_b64_tr_b16 v[52:53], v247 offset:0
  ds_read_b64_tr_b16 v[54:55], v247 offset:1024
  ds_read_b64_tr_b16 v[80:81], v245 offset:2048
  ds_read_b64_tr_b16 v[82:83], v246 offset:1024
  ds_read_b64_tr_b16 v[84:85], v247 offset:2048
  ds_read_b64_tr_b16 v[86:87], v248 offset:1024
  ds_read_b64_tr_b16 v[56:57], v245 offset:3584
  ds_read_b64_tr_b16 v[58:59], v245 offset:4608
  ds_read_b64_tr_b16 v[60:61], v247 offset:3584
  ds_read_b64_tr_b16 v[62:63], v247 offset:4608
  ds_read_b64_tr_b16 v[88:89], v245 offset:5632
  ds_read_b64_tr_b16 v[90:91], v246 offset:4608
  ds_read_b64_tr_b16 v[92:93], v247 offset:5632
  ds_read_b64_tr_b16 v[94:95], v248 offset:4608
  ds_read_b64_tr_b16 v[64:65], v245 offset:7168
  ds_read_b64_tr_b16 v[66:67], v245 offset:8192
  ds_read_b64_tr_b16 v[68:69], v247 offset:7168
  ds_read_b64_tr_b16 v[70:71], v247 offset:8192
  ds_read_b64_tr_b16 v[16:17], v245 offset:9216
  ds_read_b64_tr_b16 v[18:19], v246 offset:8192
  ds_read_b64_tr_b16 v[20:21], v247 offset:9216
  ds_read_b64_tr_b16 v[22:23], v248 offset:8192
  ds_read_b64_tr_b16 v[24:25], v245 offset:10752
  ds_read_b64_tr_b16 v[26:27], v245 offset:11776
  ds_read_b64_tr_b16 v[28:29], v247 offset:10752
  ds_read_b64_tr_b16 v[30:31], v247 offset:11776
  ds_read_b64_tr_b16 v[32:33], v245 offset:12800
  ds_read_b64_tr_b16 v[34:35], v246 offset:11776
  ds_read_b64_tr_b16 v[36:37], v247 offset:12800
  ds_read_b64_tr_b16 v[38:39], v248 offset:11776
  ds_read_b64_tr_b16 v[96:97], v245 offset:14336
  ds_read_b64_tr_b16 v[98:99], v245 offset:15360
  ds_read_b64_tr_b16 v[100:101], v247 offset:14336
  ds_read_b64_tr_b16 v[102:103], v247 offset:15360
  ds_read_b64_tr_b16 v[72:73], v245 offset:16384
  ds_read_b64_tr_b16 v[74:75], v246 offset:15360
  ds_read_b64_tr_b16 v[76:77], v247 offset:16384
  ds_read_b64_tr_b16 v[78:79], v248 offset:15360
  ds_read_b64_tr_b16 v[112:113], v245 offset:17920
  ds_read_b64_tr_b16 v[114:115], v245 offset:18944
  ds_read_b64_tr_b16 v[116:117], v247 offset:17920
  ds_read_b64_tr_b16 v[118:119], v247 offset:18944
  ds_read_b64_tr_b16 v[120:121], v245 offset:19968
  ds_read_b64_tr_b16 v[122:123], v246 offset:18944
  ds_read_b64_tr_b16 v[124:125], v247 offset:19968
  ds_read_b64_tr_b16 v[126:127], v248 offset:18944
  ds_read_b64_tr_b16 v[128:129], v245 offset:21504
  ds_read_b64_tr_b16 v[130:131], v245 offset:22528
  ds_read_b64_tr_b16 v[132:133], v247 offset:21504
  ds_read_b64_tr_b16 v[134:135], v247 offset:22528
  ds_read_b64_tr_b16 v[136:137], v245 offset:23552
  ds_read_b64_tr_b16 v[138:139], v246 offset:22528
  ds_read_b64_tr_b16 v[140:141], v247 offset:23552
  ds_read_b64_tr_b16 v[142:143], v248 offset:22528
  ds_read_b64_tr_b16 v[104:105], v245 offset:25088
  ds_read_b64_tr_b16 v[106:107], v245 offset:26112
  ds_read_b64_tr_b16 v[108:109], v247 offset:25088
  ds_read_b64_tr_b16 v[110:111], v247 offset:26112
  ds_read_b64_tr_b16 v[40:41], v245 offset:27136
  ds_read_b64_tr_b16 v[42:43], v246 offset:26112
  ds_read_b64_tr_b16 v[44:45], v247 offset:27136
  ds_read_b64_tr_b16 v[46:47], v248 offset:26112
  v_mov_b32 v10, 155648
  s_mov_b32 s66, 1048576
LP_f5140:
  ds_read_b32 v11, v10 offset:20
  s_sub_u32 s66, s66, 1
  s_waitcnt lgkmcnt(0)
  v_readfirstlane_b32 s3, v11
  s_nop 0
  s_cmp_lt_u32 s3, 262144
  s_cselect_b32 s3, s66, 0
  s_cmp_lg_u32 s3, 0
  s_cbranch_scc1 LP_f5140
  s_setprio 3
  s_add_u32 s3, s49, 0
  buffer_load_dwordx4 v[144:147], v2, s[36:39], s3 offen offset:0 sc1
  buffer_load_dwordx4 v[148:151], v2, s[36:39], s3 offen offset:1024 sc1
  s_add_u32 s3, s49, 131072
  buffer_load_dwordx4 v[152:155], v2, s[36:39], s3 offen offset:0 sc1
  buffer_load_dwordx4 v[156:159], v2, s[36:39], s3 offen offset:1024 sc1
  s_add_u32 s3, s49, 262144
  buffer_load_dwordx4 v[160:163], v2, s[36:39], s3 offen offset:0 sc1
  buffer_load_dwordx4 v[164:167], v2, s[36:39], s3 offen offset:1024 sc1
  s_add_u32 s3, s49, 393216
  buffer_load_dwordx4 v[168:171], v2, s[36:39], s3 offen offset:0 sc1
  buffer_load_dwordx4 v[172:175], v2, s[36:39], s3 offen offset:1024 sc1
  buffer_load_dword v6, v250, s[36:39], s50 offen sc1
  v_mov_b32 v7, v251
  v_mov_b32 v9, v252
  v_mov_b32 v0, v253
  s_mov_b32 s66, 65536
  s_waitcnt vmcnt(8)
  v_xor_b32 v147, s5, v147
  s_waitcnt vmcnt(7)
  v_xor_b32 v151, s5, v151
  v_or3_b32 v3, v147, v151, 0
  s_waitcnt vmcnt(6)
  v_xor_b32 v155, s5, v155
  s_waitcnt vmcnt(5)
  v_xor_b32 v159, s5, v159
  v_or3_b32 v3, v155, v159, v3
  v_cmp_lt_u32 vcc, 0xffff, v3
  s_nop 0
  s_cmp_lg_u64 vcc, 0
  s_cbranch_scc0 EL_f5141
LP_f5143:
  s_add_u32 s3, s49, 0
  buffer_load_dwordx4 v[144:147], v2, s[36:39], s3 offen offset:0 sc1
  buffer_load_dwordx4 v[148:151], v2, s[36:39], s3 offen offset:1024 sc1
  s_add_u32 s3, s49, 131072
  buffer_load_dwordx4 v[152:155], v2, s[36:39], s3 offen offset:0 sc1
  buffer_load_dwordx4 v[156:159], v2, s[36:39], s3 offen offset:1024 sc1
  s_waitcnt vmcnt(3)
  v_xor_b32 v147, s5, v147
  s_waitcnt vmcnt(2)
  v_xor_b32 v151, s5, v151
  v_or3_b32 v3, v147, v151, 0
  s_waitcnt vmcnt(1)
  v_xor_b32 v155, s5, v155
  s_waitcnt vmcnt(0)
  v_xor_b32 v159, s5, v159
  v_or3_b32 v3, v155, v159, v3
  v_cmp_lt_u32 vcc, 0xffff, v3
  s_sub_u32 s66, s66, 1
  s_cmp_lg_u64 vcc, 0
  s_cselect_b32 s3, s66, 0
  s_cmp_gt_i32 s3, 0
  s_cbranch_scc1 LP_f5143
EL_f5141:
  v_mfma_f32_32x32x16_bf16 v[224:239], v[52:55], v[144:147], 0
  s_add_u32 s3, s49, 524288
  buffer_load_dwordx4 v[176:179], v2, s[36:39], s3 offen offset:0 sc1
  buffer_load_dwordx4 v[180:183], v2, s[36:39], s3 offen offset:1024 sc1
  v_mfma_f32_32x32x16_bf16 v[208:223], v[48:51], v[144:147], 0
  v_mfma_f32_32x32x16_bf16 v[224:239], v[84:87], v[148:151], v[224:239]
  s_add_u32 s3, s49, 655360
  buffer_load_dwordx4 v[184:187], v2, s[36:39], s3 offen offset:0 sc1
  buffer_load_dwordx4 v[188:191], v2, s[36:39], s3 offen offset:1024 sc1
  v_mfma_f32_32x32x16_bf16 v[208:223], v[80:83], v[148:151], v[208:223]
  v_mfma_f32_32x32x16_bf16 v[224:239], v[60:63], v[152:155], v[224:239]
  s_waitcnt vmcnt(8)
  v_xor_b32 v163, s5, v163
  s_waitcnt vmcnt(7)
  v_xor_b32 v167, s5, v167
  v_mfma_f32_32x32x16_bf16 v[208:223], v[56:59], v[152:155], v[208:223]
  v_or3_b32 v3, v163, v167, 0
  s_waitcnt vmcnt(6)
  v_xor_b32 v171, s5, v171
  v_mfma_f32_32x32x16_bf16 v[224:239], v[92:95], v[156:159], v[224:239]
  s_waitcnt vmcnt(5)
  v_xor_b32 v175, s5, v175
  v_or3_b32 v3, v171, v175, v3
  v_mfma_f32_32x32x16_bf16 v[208:223], v[88:91], v[156:159], v[208:223]
  v_cmp_lt_u32 vcc, 0xffff, v3
  s_nop 0
  s_cmp_lg_u64 vcc, 0
  s_cbranch_scc0 EL_f5144
LP_f5146:
  s_add_u32 s3, s49, 262144
  buffer_load_dwordx4 v[160:163], v2, s[36:39], s3 offen offset:0 sc1
  buffer_load_dwordx4 v[164:167], v2, s[36:39], s3 offen offset:1024 sc1
  s_add_u32 s3, s49, 393216
  buffer_load_dwordx4 v[168:171], v2, s[36:39], s3 offen offset:0 sc1
  buffer_load_dwordx4 v[172:175], v2, s[36:39], s3 offen offset:1024 sc1
  s_waitcnt vmcnt(3)
  v_xor_b32 v163, s5, v163
  s_waitcnt vmcnt(2)
  v_xor_b32 v167, s5, v167
  v_or3_b32 v3, v163, v167, 0
  s_waitcnt vmcnt(1)
  v_xor_b32 v171, s5, v171
  s_waitcnt vmcnt(0)
  v_xor_b32 v175, s5, v175
  v_or3_b32 v3, v171, v175, v3
  v_cmp_lt_u32 vcc, 0xffff, v3
  s_sub_u32 s66, s66, 1
  s_cmp_lg_u64 vcc, 0
  s_cselect_b32 s3, s66, 0
  s_cmp_gt_i32 s3, 0
  s_cbranch_scc1 LP_f5146
EL_f5144:
  v_mfma_f32_32x32x16_bf16 v[224:239], v[68:71], v[160:163], v[224:239]
  s_add_u32 s3, s49, 786432
  buffer_load_dwordx4 v[192:195], v2, s[36:39], s3 offen offset:0 sc1
  buffer_load_dwordx4 v[196:199], v2, s[36:39], s3 offen offset:1024 sc1
  v_mfma_f32_32x32x16_bf16 v[208:223], v[64:67], v[160:163], v[208:223]
  v_mfma_f32_32x32x16_bf16 v[224:239], v[20:23], v[164:167], v[224:239]
  s_add_u32 s3, s49, 917504
  buffer_load_dwordx4 v[200:203], v2, s[36:39], s3 offen offset:0 sc1
  buffer_load_dwordx4 v[204:207], v2, s[36:39], s3 offen offset:1024 sc1
  v_mfma_f32_32x32x16_bf16 v[208:223], v[16:19], v[164:167], v[208:223]
  v_mfma_f32_32x32x16_bf16 v[224:239], v[28:31], v[168:171], v[224:239]
  s_waitcnt vmcnt(7)
  v_xor_b32 v179, s5, v179
  s_waitcnt vmcnt(6)
  v_xor_b32 v183, s5, v183
  v_mfma_f32_32x32x16_bf16 v[208:223], v[24:27], v[168:171], v[208:223]
  v_or3_b32 v3, v179, v183, 0
  s_waitcnt vmcnt(5)
  v_xor_b32 v187, s5, v187
  v_mfma_f32_32x32x16_bf16 v[224:239], v[36:39], v[172:175], v[224:239]
  s_waitcnt vmcnt(4)
  v_xor_b32 v191, s5, v191
  v_or3_b32 v3, v187, v191, v3
  v_mfma_f32_32x32x16_bf16 v[208:223], v[32:35], v[172:175], v[208:223]
  v_cmp_lt_u32 vcc, 0xffff, v3
  s_nop 0
  s_cmp_lg_u64 vcc, 0
  s_cbranch_scc0 EL_f5147
LP_f5149:
  s_add_u32 s3, s49, 524288
  buffer_load_dwordx4 v[176:179], v2, s[36:39], s3 offen offset:0 sc1
  buffer_load_dwordx4 v[180:183], v2, s[36:39], s3 offen offset:1024 sc1
  s_add_u32 s3, s49, 655360
  buffer_load_dwordx4 v[184:187], v2, s[36:39], s3 offen offset:0 sc1
  buffer_load_dwordx4 v[188:191], v2, s[36:39], s3 offen offset:1024 sc1
  s_waitcnt vmcnt(3)
  v_xor_b32 v179, s5, v179
  s_waitcnt vmcnt(2)
  v_xor_b32 v183, s5, v183
  v_or3_b32 v3, v179, v183, 0
  s_waitcnt vmcnt(1)
  v_xor_b32 v187, s5, v187
  s_waitcnt vmcnt(0)
  v_xor_b32 v191, s5, v191
  v_or3_b32 v3, v187, v191, v3
  v_cmp_lt_u32 vcc, 0xffff, v3
  s_sub_u32 s66, s66, 1
  s_cmp_lg_u64 vcc, 0
  s_cselect_b32 s3, s66, 0
  s_cmp_gt_i32 s3, 0
  s_cbranch_scc1 LP_f5149
EL_f5147:
  v_mfma_f32_32x32x16_bf16 v[224:239], v[100:103], v[176:179], v[224:239]
  v_mfma_f32_32x32x16_bf16 v[208:223], v[96:99], v[176:179], v[208:223]
  v_mfma_f32_32x32x16_bf16 v[224:239], v[76:79], v[180:183], v[224:239]
  v_mfma_f32_32x32x16_bf16 v[208:223], v[72:75], v[180:183], v[208:223]
  ds_read_b32 v5, v10
  v_mfma_f32_32x32x16_bf16 v[224:239], v[116:119], v[184:187], v[224:239]
  s_waitcnt vmcnt(3)
  v_xor_b32 v195, s5, v195
  s_waitcnt vmcnt(2)
  v_xor_b32 v199, s5, v199
  v_mfma_f32_32x32x16_bf16 v[208:223], v[112:115], v[184:187], v[208:223]
  v_or3_b32 v3, v195, v199, 0
  s_waitcnt vmcnt(1)
  v_xor_b32 v203, s5, v203
  v_mfma_f32_32x32x16_bf16 v[224:239], v[124:127], v[188:191], v[224:239]
  s_waitcnt vmcnt(0)
  v_xor_b32 v207, s5, v207
  v_or3_b32 v3, v203, v207, v3
  v_mfma_f32_32x32x16_bf16 v[208:223], v[120:123], v[188:191], v[208:223]
  v_cmp_lt_u32 vcc, 0xffff, v3
  s_nop 0
  s_cmp_lg_u64 vcc, 0
  s_cbranch_scc0 EL_f5150
LP_f5152:
  s_add_u32 s3, s49, 786432
  buffer_load_dwordx4 v[192:195], v2, s[36:39], s3 offen offset:0 sc1
  buffer_load_dwordx4 v[196:199], v2, s[36:39], s3 offen offset:1024 sc1
  s_add_u32 s3, s49, 917504
  buffer_load_dwordx4 v[200:203], v2, s[36:39], s3 offen offset:0 sc1
  buffer_load_dwordx4 v[204:207], v2, s[36:39], s3 offen offset:1024 sc1
  s_waitcnt vmcnt(3)
  v_xor_b32 v195, s5, v195
  s_waitcnt vmcnt(2)
  v_xor_b32 v199, s5, v199
  v_or3_b32 v3, v195, v199, 0
  s_waitcnt vmcnt(1)
  v_xor_b32 v203, s5, v203
  s_waitcnt vmcnt(0)
  v_xor_b32 v207, s5, v207
  v_or3_b32 v3, v203, v207, v3
  v_cmp_lt_u32 vcc, 0xffff, v3
  s_sub_u32 s66, s66, 1
  s_cmp_lg_u64 vcc, 0
  s_cselect_b32 s3, s66, 0
  s_cmp_gt_i32 s3, 0
  s_cbranch_scc1 LP_f5152
EL_f5150:
  v_mfma_f32_32x32x16_bf16 v[224:239], v[132:135], v[192:195], v[224:239]
  buffer_load_dwordx4 v[240:243], v2, s[36:39], s73 offen offset:0 sc1
  buffer_load_dwordx4 v[244:247], v2, s[36:39], s73 offen offset:1024 sc1
  buffer_load_dwordx4 v[248:251], v2, s[36:39], s73 offen offset:2048 sc1
  buffer_load_dwordx4 v[252:255], v2, s[36:39], s73 offen offset:3072 sc1
  v_mfma_f32_32x32x16_bf16 v[224:239], v[140:143], v[196:199], v[224:239]
  v_mfma_f32_32x32x16_bf16 v[224:239], v[108:111], v[200:203], v[224:239]
  v_mfma_f32_32x32x16_bf16 v[224:239], v[44:47], v[204:207], v[224:239]
  v_mfma_f32_32x32x16_bf16 v[208:223], v[128:131], v[192:195], v[208:223]
  v_mfma_f32_32x32x16_bf16 v[208:223], v[136:139], v[196:199], v[208:223]
  v_mfma_f32_32x32x16_bf16 v[208:223], v[104:107], v[200:203], v[208:223]
  s_nop 8
  ds_write_b128 v8, v[224:227] offset:0
  ds_write_b128 v8, v[228:231] offset:1024
  v_mfma_f32_32x32x16_bf16 v[208:223], v[40:43], v[204:207], v[208:223]
  ds_write_b128 v8, v[232:235] offset:2048
  ds_write_b128 v8, v[236:239] offset:3072
  s_waitcnt lgkmcnt(4)
  v_readfirstlane_b32 s3, v5
  s_nop 0
  s_cmp_lt_u32 s3, 1056
  s_cbranch_scc0 EL_f5153
  s_mov_b32 s59, s66
  s_setprio 0
  v_mov_b32 v4, 155648
  s_mov_b32 s66, 1048576
LP_f5155:
  ds_read_b32 v5, v4 offset:0
  s_sub_u32 s66, s66, 1
  s_waitcnt lgkmcnt(0)
  v_readfirstlane_b32 s3, v5
  s_nop 0
  s_cmp_lt_u32 s3, 1056
  s_cselect_b32 s3, s66, 0
  s_cmp_lg_u32 s3, 0
  s_cbranch_scc1 LP_f5155
  s_mov_b32 s66, s59
EL_f5153:
  ds_read_b128 v[144:147], v0 offset:0
  ds_read_b128 v[160:163], v0 offset:8192
  ds_read_b128 v[148:151], v0 offset:1024
  ds_read_b128 v[164:167], v0 offset:9216
  ds_read_b128 v[152:155], v0 offset:2048
  ds_read_b128 v[168:171], v0 offset:10240
  ds_read_b128 v[156:159], v0 offset:3072
  ds_read_b128 v[172:175], v0 offset:11264
  s_waitcnt vmcnt(3)
  v_perm_b32 v10, v241, v240, s15
  v_xor_b32 v10, s5, v10
  v_or_b32 v3, 0, v10
  s_waitcnt vmcnt(2)
  v_perm_b32 v10, v245, v244, s15
  v_xor_b32 v10, s5, v10
  v_or_b32 v3, v3, v10
  s_waitcnt vmcnt(1)
  v_perm_b32 v10, v249, v248, s15
  v_xor_b32 v10, s5, v10
  v_or_b32 v3, v3, v10
  s_waitcnt vmcnt(0)
  v_perm_b32 v10, v253, v252, s15
  v_xor_b32 v10, s5, v10
  v_or_b32 v3, v3, v10
  v_cmp_ne_u32 vcc, 0, v3
  s_nop 0
  s_cmp_lg_u64 vcc, 0
  s_cbranch_scc0 EL_f5156
LP_f5158:
  buffer_load_dwordx4 v[240:243], v2, s[36:39], s73 offen offset:0 sc1
  buffer_load_dwordx4 v[244:247], v2, s[36:39], s73 offen offset:1024 sc1
  buffer_load_dwordx4 v[248:251], v2, s[36:39], s73 offen offset:2048 sc1
  buffer_load_dwordx4 v[252:255], v2, s[36:39], s73 offen offset:3072 sc1
  s_waitcnt vmcnt(3)
  v_perm_b32 v10, v241, v240, s15
  v_xor_b32 v10, s5, v10
  v_or_b32 v3, 0, v10
  s_waitcnt vmcnt(2)
  v_perm_b32 v10, v245, v244, s15
  v_xor_b32 v10, s5, v10
  v_or_b32 v3, v3, v10
  s_waitcnt vmcnt(1)
  v_perm_b32 v10, v249, v248, s15
  v_xor_b32 v10, s5, v10
  v_or_b32 v3, v3, v10
  s_waitcnt vmcnt(0)
  v_perm_b32 v10, v253, v252, s15
  v_xor_b32 v10, s5, v10
  v_or_b32 v3, v3, v10
  v_cmp_ne_u32 vcc, 0, v3
  s_sub_u32 s66, s66, 1
  s_cmp_lg_u64 vcc, 0
  s_cselect_b32 s3, s66, 0
  s_cmp_gt_i32 s3, 0
  s_cbranch_scc1 LP_f5158
EL_f5156:
  v_sub_f32 v10, 1.0, v6
  v_sub_f32 v11, 1.0, v6
  v_mov_b32 v4, v6
  v_mov_b32 v5, v6
  v_and_b32 v240, 0xffffff00, v240
  v_and_b32 v241, 0xffffff00, v241
  v_and_b32 v244, 0xffffff00, v244
  v_and_b32 v245, 0xffffff00, v245
  v_and_b32 v248, 0xffffff00, v248
  v_and_b32 v249, 0xffffff00, v249
  v_and_b32 v252, 0xffffff00, v252
  v_and_b32 v253, 0xffffff00, v253
  s_waitcnt lgkmcnt(8)
  s_barrier
  ds_read_b128 v[48:51], v9 offset:0
  ds_read_b128 v[52:55], v9 offset:1024
  ds_read_b128 v[56:59], v9 offset:2048
  ds_read_b128 v[60:63], v9 offset:3072
  s_waitcnt lgkmcnt(10)
  v_pk_add_f32 v[144:145], v[144:145], v[160:161]
  v_pk_add_f32 v[146:147], v[146:147], v[162:163]
  s_waitcnt lgkmcnt(8)
  v_pk_add_f32 v[148:149], v[148:149], v[164:165]
  v_pk_add_f32 v[150:151], v[150:151], v[166:167]
  s_waitcnt lgkmcnt(6)
  v_pk_add_f32 v[152:153], v[152:153], v[168:169]
  v_pk_add_f32 v[154:155], v[154:155], v[170:171]
  s_waitcnt lgkmcnt(4)
  v_pk_add_f32 v[156:157], v[156:157], v[172:173]
  v_pk_add_f32 v[158:159], v[158:159], v[174:175]
  v_pk_add_f32 v[240:241], v[240:241], v[144:145]
  v_pk_add_f32 v[242:243], v[242:243], v[146:147]
  v_pk_add_f32 v[244:245], v[244:245], v[148:149]
  v_pk_add_f32 v[246:247], v[246:247], v[150:151]
  v_pk_mul_f32 v[240:241], v[240:241], v[10:11]
  v_pk_mul_f32 v[242:243], v[242:243], v[10:11]
  v_pk_mul_f32 v[244:245], v[244:245], v[10:11]
  v_pk_mul_f32 v[246:247], v[246:247], v[10:11]
  s_waitcnt lgkmcnt(3)
  v_pk_add_f32 v[208:209], v[208:209], v[48:49]
  v_pk_add_f32 v[210:211], v[210:211], v[50:51]
  s_waitcnt lgkmcnt(2)
  v_pk_add_f32 v[212:213], v[212:213], v[52:53]
  v_pk_add_f32 v[214:215], v[214:215], v[54:55]
  v_pk_fma_f32 v[208:209], v[208:209], v[4:5], v[240:241]
  v_pk_fma_f32 v[210:211], v[210:211], v[4:5], v[242:243]
  v_pk_fma_f32 v[212:213], v[212:213], v[4:5], v[244:245]
  v_pk_fma_f32 v[214:215], v[214:215], v[4:5], v[246:247]
  v_cvt_pk_bf16_f32 v48, v208, v209
  v_cvt_pk_bf16_f32 v49, v210, v211
  v_cvt_pk_bf16_f32 v50, v212, v213
  v_cvt_pk_bf16_f32 v51, v214, v215
  s_nop 0
  v_permlane32_swap_b32 v48, v50
  v_permlane32_swap_b32 v49, v51
  buffer_store_dwordx4 v[48:51], v7, s[32:35], 0 offen offset:0
  v_pk_add_f32 v[248:249], v[248:249], v[152:153]
  v_pk_add_f32 v[250:251], v[250:251], v[154:155]
  v_pk_add_f32 v[252:253], v[252:253], v[156:157]
  v_pk_add_f32 v[254:255], v[254:255], v[158:159]
  v_pk_mul_f32 v[248:249], v[248:249], v[10:11]
  v_pk_mul_f32 v[250:251], v[250:251], v[10:11]
  v_pk_mul_f32 v[252:253], v[252:253], v[10:11]
  v_pk_mul_f32 v[254:255], v[254:255], v[10:11]
  s_waitcnt lgkmcnt(1)
  v_pk_add_f32 v[216:217], v[216:217], v[56:57]
  v_pk_add_f32 v[218:219], v[218:219], v[58:59]
  s_waitcnt lgkmcnt(0)
  v_pk_add_f32 v[220:221], v[220:221], v[60:61]
  v_pk_add_f32 v[222:223], v[222:223], v[62:63]
  v_pk_fma_f32 v[216:217], v[216:217], v[4:5], v[248:249]
  v_pk_fma_f32 v[218:219], v[218:219], v[4:5], v[250:251]
  v_pk_fma_f32 v[220:221], v[220:221], v[4:5], v[252:253]
  v_pk_fma_f32 v[222:223], v[222:223], v[4:5], v[254:255]
  v_cvt_pk_bf16_f32 v56, v216, v217
  v_cvt_pk_bf16_f32 v57, v218, v219
  v_cvt_pk_bf16_f32 v58, v220, v221
  v_cvt_pk_bf16_f32 v59, v222, v223
  s_nop 0
  v_permlane32_swap_b32 v56, v58
  v_permlane32_swap_b32 v57, v59
  buffer_store_dwordx4 v[56:59], v7, s[32:35], 0 offen offset:32
  s_endpgm
EL_f5108:
  s_setprio 2
  s_lshl_b32 s60, s56, 6
  v_lshlrev_b32 v225, 1, v1
  v_add_u32 v225, s60, v225
  global_load_ushort v224, v225, s[14:15]
  s_lshl_b32 s3, s57, 7
  v_add_u32 v227, s3, v225
  global_load_ushort v226, v227, s[14:15]
  s_sub_u32 s72, 1605632, s60
  s_add_u32 s32, s12, s60
  s_addc_u32 s33, s13, 0
  s_mov_b32 s34, s72
  s_mov_b32 s35, 0x20000
  v_subrev_u32 v240, 57344, v240
  v_subrev_u32 v241, 57344, v241
  v_subrev_u32 v242, 86016, v242
  v_subrev_u32 v243, 86016, v243
  v_lshrrev_b32 v250, 1, v3
  v_lshlrev_b32 v250, 6, v250
  v_lshl_add_u32 v250, v4, 3, v250
  v_lshl_add_u32 v249, v5, 7, v250
  v_add_u32 v249, 98304, v249
  v_lshrrev_b32 v5, 5, v1
  v_lshl_add_u32 v5, v5, 2, v3
  v_lshl_add_u32 v7, v5, 7, v250
  v_xor_b32 v250, 64, v249
  v_add_u32 v7, s61, v7
  s_lshr_b32 s3, s67, 1
  s_lshl_b32 s3, s3, 6
  v_xor_b32 v7, s3, v7
  v_xor_b32 v8, 64, v7
  v_lshrrev_b32 v3, 3, v1
  v_mul_u32_u24 v6, 896, v3
  v_and_b32 v3, 127, v244
  v_add_u32 v6, v6, v3
  s_cmp_eq_u32 s54, 3
  s_cbranch_scc0 EL_f5159
  s_add_u32 s44, s18, 0
  s_addc_u32 s45, s19, 0
  s_mov_b32 s46, 896
  s_mov_b32 s47, 0x20000
  s_add_u32 s3, s63, 5
  s_lshl_b32 s3, s3, 7
  v_add_u32 v3, s3, v2
  v_subrev_u32 v4, 896, v3
  v_min_u32 v3, v3, v4
  v_subrev_u32 v4, 896, v3
  v_min_u32 v3, v3, v4
  s_lshr_b32 s3, s61, 1
  s_add_u32 m0, s3, 159744
  v_lshrrev_b32 v9, 5, v1
  v_lshlrev_b32 v9, 4, v9
  v_add_u32 v9, m0, v9
  buffer_load_dwordx4 v3, s[44:47], 0 offen lds
EL_f5159:
  s_mul_i32 s4, s55, 56
  s_add_u32 s4, s4, s56
  s_lshl_b32 s4, s4, 11
  s_add_u32 s4, s4, 7340032
  s_and_b32 s6, s2, 7
  s_lshl_b32 s6, s6, 1
  s_bfe_u32 s3, s2, 0x10003
  s_add_u32 s6, s6, s3
  s_bfe_u32 s5, s2, 0x10004
  s_lshr_b32 s7, s2, 5
  s_lshl_b32 s59, s5, 2
  s_add_u32 s59, s59, s67
  s_mul_i32 s59, s59, 200704
  s_lshl_b32 s3, s7, 7
  s_add_u32 s59, s59, s3
  s_sub_u32 s60, 200704, s3
  s_cmp_lt_u32 s2, 224
  s_cselect_b32 s60, s60, 0
  s_add_u32 s44, s16, s59
  s_addc_u32 s45, s17, 0
  s_mov_b32 s46, s60
  s_mov_b32 s47, 0x20000
  s_mul_i32 s59, s67, 14336
  s_add_u32 s59, s59, s3
  s_sub_u32 s60, 401408, s59
  s_cmp_lt_u32 s2, 224
  s_cselect_b32 s60, s60, 0
  s_add_u32 s48, s8, s59
  s_addc_u32 s49, s9, 0
  s_mov_b32 s50, s60
  s_mov_b32 s51, 0x20000
  v_mov_b32 v228, 0
  v_mov_b32 v229, 0
  v_mov_b32 v230, 0
  v_mov_b32 v231, 0
  v_mov_b32 v232, 0
  v_mov_b32 v233, 0
  v_mov_b32 v234, 0
  v_mov_b32 v235, 0
  v_mov_b32 v236, 0
  v_mov_b32 v237, 0
  v_mov_b32 v3, 0x3f80
  v_cmp_gt_u32 vcc, 32, v1
  s_nop 1
  v_cndmask_b32 v230, 0, v3, vcc
  v_cndmask_b32 v234, v3, v234, vcc
  v_mov_b32 v225, 0
  v_mov_b32 v227, 0
  s_waitcnt vmcnt(7) lgkmcnt(0)
  s_barrier
  s_add_u32 m0, s61, 65536
  s_lshl_b32 s64, s63, 7
  buffer_load_dwordx4 v240, s[24:27], s64 offen lds
  buffer_load_dwordx4 v241, s[24:27], s64 offen offset:1024 lds
  ds_read_b128 v[16:19], v245 offset:0
  ds_read_b128 v[20:23], v246 offset:0
  ds_read_b128 v[24:27], v247 offset:0
  ds_read_b128 v[28:31], v248 offset:0
  s_add_u32 m0, s61, 73728
  s_add_u32 s64, s64, 57344
  buffer_load_dwordx4 v240, s[24:27], s64 offen lds
  buffer_load_dwordx4 v241, s[24:27], s64 offen offset:1024 lds
  s_add_u32 m0, s61, 81920
  s_mul_i32 s64, s63, 172032
  buffer_load_dwordx4 v242, s[28:31], s64 offen lds
  buffer_load_dwordx4 v243, s[28:31], s64 offen offset:1024 lds
  s_add_u32 m0, s61, 90112
  s_add_u32 s64, s64, 86016
  buffer_load_dwordx4 v242, s[28:31], s64 offen lds
  buffer_load_dwordx4 v243, s[28:31], s64 offen offset:1024 lds
  s_add_u32 s63, s63, 1
  s_cmp_eq_u32 s63, 7
  s_cselect_b32 s63, 0, s63
  s_waitcnt vmcnt(10) lgkmcnt(0)
  s_barrier
  s_add_u32 m0, s61, 0
  s_lshl_b32 s64, s63, 7
  buffer_load_dwordx4 v240, s[24:27], s64 offen lds
  buffer_load_dwordx4 v241, s[24:27], s64 offen offset:1024 lds
  ds_read_b128 v[32:35], v245 offset:32768
  ds_read_b128 v[36:39], v246 offset:32768
  ds_read_b128 v[40:43], v247 offset:32768
  ds_read_b128 v[44:47], v248 offset:32768
  s_add_u32 m0, s61, 8192
  s_add_u32 s64, s64, 57344
  buffer_load_dwordx4 v240, s[24:27], s64 offen lds
  buffer_load_dwordx4 v241, s[24:27], s64 offen offset:1024 lds
  s_add_u32 m0, s61, 16384
  s_mul_i32 s64, s63, 172032
  buffer_load_dwordx4 v242, s[28:31], s64 offen lds
  buffer_load_dwordx4 v243, s[28:31], s64 offen offset:1024 lds
  s_add_u32 m0, s61, 24576
  s_add_u32 s64, s64, 86016
  buffer_load_dwordx4 v242, s[28:31], s64 offen lds
  buffer_load_dwordx4 v243, s[28:31], s64 offen offset:1024 lds
  s_add_u32 s63, s63, 1
  s_cmp_eq_u32 s63, 7
  s_cselect_b32 s63, 0, s63
  v_readfirstlane_b32 s65, v253
  s_nop 0
  s_mul_i32 s65, s65, 0x9E3779B1
  s_add_u32 s65, s65, 0x7F4A7C15
  v_mov_b32 v12, s65
  v_mov_b32 v13, s65
  v_mov_b32 v14, s65
  v_mov_b32 v15, s65
  s_waitcnt vmcnt(8) lgkmcnt(0)
  s_barrier
  s_add_u32 m0, s61, 32768
  s_lshl_b32 s64, s63, 7
  buffer_load_dwordx4 v240, s[24:27], s64 offen lds
  buffer_load_dwordx4 v241, s[24:27], s64 offen offset:1024 lds
  v_add_u32 v245, 32768, v245
  v_add_u32 v246, 32768, v246
  v_add_u32 v247, 32768, v247
  v_add_u32 v248, 32768, v248
  ds_read_b128 v[48:51], v245 offset:32768
  ds_read_b128 v[52:55], v246 offset:32768
  ds_read_b128 v[56:59], v247 offset:32768
  ds_read_b128 v[60:63], v248 offset:32768
  s_add_u32 m0, s61, 40960
  s_add_u32 s64, s64, 57344
  buffer_load_dwordx4 v240, s[24:27], s64 offen lds
  buffer_load_dwordx4 v241, s[24:27], s64 offen offset:1024 lds
  s_add_u32 m0, s61, 49152
  s_mul_i32 s64, s63, 172032
  buffer_load_dwordx4 v242, s[28:31], s64 offen lds
  buffer_load_dwordx4 v243, s[28:31], s64 offen offset:1024 lds
  s_add_u32 m0, s61, 57344
  s_add_u32 s64, s64, 86016
  buffer_load_dwordx4 v242, s[28:31], s64 offen lds
  buffer_load_dwordx4 v243, s[28:31], s64 offen offset:1024 lds
  s_add_u32 s63, s63, 1
  s_cmp_eq_u32 s63, 7
  s_cselect_b32 s63, 0, s63
  v_mfma_f32_32x32x16_bf16 v[128:143], v[224:227], v[230:233], 0
  v_mfma_f32_32x32x16_bf16 v[144:159], v[224:227], v[234:237], 0
  v_mfma_f32_32x32x16_bf16 v[160:175], v[224:227], v[228:231], 0
  v_mfma_f32_32x32x16_bf16 v[176:191], v[224:227], v[232:235], 0
  s_waitcnt vmcnt(8) lgkmcnt(0)
  s_barrier
  s_add_u32 m0, s61, 65536
  s_lshl_b32 s64, s63, 7
  buffer_load_dwordx4 v240, s[24:27], s64 offen lds
  buffer_load_dwordx4 v241, s[24:27], s64 offen offset:1024 lds
  v_subrev_u32 v245, 32768, v245
  v_subrev_u32 v246, 32768, v246
  v_subrev_u32 v247, 32768, v247
  v_subrev_u32 v248, 32768, v248
  ds_read_b128 v[64:67], v245 offset:0
  ds_read_b128 v[68:71], v246 offset:0
  ds_read_b128 v[72:75], v247 offset:0
  ds_read_b128 v[76:79], v248 offset:0
  s_add_u32 m0, s61, 73728
  s_add_u32 s64, s64, 57344
  buffer_load_dwordx4 v240, s[24:27], s64 offen lds
  buffer_load_dwordx4 v241, s[24:27], s64 offen offset:1024 lds
  s_add_u32 m0, s61, 81920
  s_mul_i32 s64, s63, 172032
  buffer_load_dwordx4 v242, s[28:31], s64 offen lds
  buffer_load_dwordx4 v243, s[28:31], s64 offen offset:1024 lds
  s_add_u32 m0, s61, 90112
  s_add_u32 s64, s64, 86016
  buffer_load_dwordx4 v242, s[28:31], s64 offen lds
  buffer_load_dwordx4 v243, s[28:31], s64 offen offset:1024 lds
  s_add_u32 s63, s63, 1
  s_cmp_eq_u32 s63, 7
  s_cselect_b32 s63, 0, s63
  s_waitcnt vmcnt(8) lgkmcnt(0)
  s_barrier
  s_add_u32 m0, s61, 0
  s_lshl_b32 s64, s63, 7
  buffer_load_dwordx4 v240, s[24:27], s64 offen lds
  buffer_load_dwordx4 v241, s[24:27], s64 offen offset:1024 lds
  ds_read_b128 v[80:83], v245 offset:32768
  ds_read_b128 v[84:87], v246 offset:32768
  ds_read_b128 v[88:91], v247 offset:32768
  ds_read_b128 v[92:95], v248 offset:32768
  s_add_u32 m0, s61, 8192
  s_add_u32 s64, s64, 57344
  buffer_load_dwordx4 v240, s[24:27], s64 offen lds
  buffer_load_dwordx4 v241, s[24:27], s64 offen offset:1024 lds
  s_add_u32 m0, s61, 16384
  s_mul_i32 s64, s63, 172032
  buffer_load_dwordx4 v242, s[28:31], s64 offen lds
  buffer_load_dwordx4 v243, s[28:31], s64 offen offset:1024 lds
  s_add_u32 m0, s61, 24576
  s_add_u32 s64, s64, 86016
  buffer_load_dwordx4 v242, s[28:31], s64 offen lds
  buffer_load_dwordx4 v243, s[28:31], s64 offen offset:1024 lds
  s_add_u32 s63, s63, 1
  s_cmp_eq_u32 s63, 7
  s_cselect_b32 s63, 0, s63
  s_waitcnt vmcnt(8) lgkmcnt(0)
  s_barrier
  v_add_u32 v245, 32768, v245
  v_add_u32 v246, 32768, v246
  v_add_u32 v247, 32768, v247
  v_add_u32 v248, 32768, v248
  ds_read_b128 v[96:99], v245 offset:32768
  ds_read_b128 v[100:103], v246 offset:32768
  ds_read_b128 v[104:107], v247 offset:32768
  ds_read_b128 v[108:111], v248 offset:32768
  s_cmp_eq_u32 s57, 1
  s_cbranch_scc0 EL_f5161
  s_add_u32 m0, s61, 98304
  s_mul_i32 s64, s63, 229376
  buffer_load_dwordx4 v244, s[32:35], s64 offen lds
  s_add_u32 s64, s64, 27648
  buffer_load_dwordx4 v244, s[32:35], s64 offen offset:1024 lds
  s_add_u32 s63, s63, 1
  s_cmp_eq_u32 s63, 7
  s_cselect_b32 s63, 0, s63
  s_add_u32 m0, s61, 106496
  s_mul_i32 s64, s63, 229376
  buffer_load_dwordx4 v244, s[32:35], s64 offen lds
  s_add_u32 s64, s64, 27648
  buffer_load_dwordx4 v244, s[32:35], s64 offen offset:1024 lds
  s_add_u32 s63, s63, 1
  s_cmp_eq_u32 s63, 7
  s_cselect_b32 s63, 0, s63
  s_add_u32 m0, s61, 114688
  s_mul_i32 s64, s63, 229376
  buffer_load_dwordx4 v244, s[32:35], s64 offen lds
  s_add_u32 s64, s64, 27648
  buffer_load_dwordx4 v244, s[32:35], s64 offen offset:1024 lds
  s_add_u32 s63, s63, 1
  s_cmp_eq_u32 s63, 7
  s_cselect_b32 s63, 0, s63
  s_add_u32 m0, s61, 122880
  s_mul_i32 s64, s63, 229376
  buffer_load_dwordx4 v244, s[32:35], s64 offen lds
  s_add_u32 s64, s64, 27648
  buffer_load_dwordx4 v244, s[32:35], s64 offen offset:1024 lds
  s_add_u32 s63, s63, 1
  s_cmp_eq_u32 s63, 7
  s_cselect_b32 s63, 0, s63
  s_waitcnt vmcnt(8)
  s_branch EN_f5162
EL_f5161:
  s_waitcnt vmcnt(0)
EN_f5162:
  s_waitcnt lgkmcnt(0)
  s_barrier
  v_subrev_u32 v245, 32768, v245
  v_subrev_u32 v246, 32768, v246
  v_subrev_u32 v247, 32768, v247
  v_subrev_u32 v248, 32768, v248
  ds_read_b128 v[112:115], v245 offset:0
  ds_read_b128 v[116:119], v246 offset:0
  ds_read_b128 v[120:123], v247 offset:0
  ds_read_b128 v[124:127], v248 offset:0
  s_cmp_eq_u32 s57, 1
  s_cbranch_scc0 EL_f5163
  s_add_u32 m0, s61, 131072
  s_mul_i32 s64, s63, 229376
  buffer_load_dwordx4 v244, s[32:35], s64 offen lds
  s_add_u32 s64, s64, 27648
  buffer_load_dwordx4 v244, s[32:35], s64 offen offset:1024 lds
  s_add_u32 s63, s63, 1
  s_cmp_eq_u32 s63, 7
  s_cselect_b32 s63, 0, s63
  s_add_u32 m0, s61, 139264
  s_mul_i32 s64, s63, 229376
  buffer_load_dwordx4 v244, s[32:35], s64 offen lds
  s_add_u32 s64, s64, 27648
  buffer_load_dwordx4 v244, s[32:35], s64 offen offset:1024 lds
  s_add_u32 s63, s63, 1
  s_cmp_eq_u32 s63, 7
  s_cselect_b32 s63, 0, s63
  s_add_u32 m0, s61, 147456
  s_mul_i32 s64, s63, 229376
  buffer_load_dwordx4 v244, s[32:35], s64 offen lds
  s_add_u32 s64, s64, 27648
  buffer_load_dwordx4 v244, s[32:35], s64 offen offset:1024 lds
  s_add_u32 s63, s63, 1
  s_cmp_eq_u32 s63, 7
  s_cselect_b32 s63, 0, s63
  s_waitcnt vmcnt(6)
EL_f5163:
  s_cmp_eq_u32 s57, 1
  s_cbranch_scc0 EL_f5165
  s_waitcnt vmcnt(0) lgkmcnt(0)
  v_mov_b32 v3, 155648
  v_mov_b32 v4, 1
  s_mov_b64 exec, 1
  ds_add_u32 v3, v4 offset:0
  s_mov_b64 exec, -1
  v_mov_b32 v3, 155648
  s_mov_b32 s66, 1048576
LP_f5167:
  ds_read_b32 v4, v3 offset:0
  s_sub_u32 s66, s66, 1
  s_waitcnt lgkmcnt(0)
  v_readfirstlane_b32 s3, v4
  s_nop 0
  s_cmp_lt_u32 s3, 1028
  s_cselect_b32 s3, s66, 0
  s_cmp_lg_u32 s3, 0
  s_cbranch_scc1 LP_f5167
  ds_read_b64_tr_b16 v[192:193], v249 offset:0
  ds_read_b64_tr_b16 v[194:195], v249 offset:512
  ds_read_b64_tr_b16 v[196:197], v249 offset:2048
  ds_read_b64_tr_b16 v[198:199], v249 offset:2560
  ds_read_b64_tr_b16 v[200:201], v249 offset:4096
  ds_read_b64_tr_b16 v[202:203], v249 offset:4608
  ds_read_b64_tr_b16 v[204:205], v249 offset:6144
  ds_read_b64_tr_b16 v[206:207], v249 offset:6656
  ds_read_b64_tr_b16 v[208:209], v249 offset:8192
  ds_read_b64_tr_b16 v[210:211], v249 offset:8704
  s_waitcnt lgkmcnt(8)
  v_mfma_f32_32x32x16_bf16 v[128:143], v[192:195], v[16:19], v[128:143]
  ds_read_b64_tr_b16 v[212:213], v249 offset:10240
  ds_read_b64_tr_b16 v[214:215], v249 offset:10752
  s_waitcnt lgkmcnt(8)
  v_mfma_f32_32x32x16_bf16 v[128:143], v[196:199], v[20:23], v[128:143]
  s_waitcnt lgkmcnt(4)
  ds_read_b64_tr_b16 v[216:217], v249 offset:12288
  ds_read_b64_tr_b16 v[218:219], v249 offset:12800
  v_mfma_f32_32x32x16_bf16 v[128:143], v[200:203], v[24:27], v[128:143]
  ds_read_b64_tr_b16 v[192:193], v249 offset:14336
  ds_read_b64_tr_b16 v[194:195], v249 offset:14848
  v_mfma_f32_32x32x16_bf16 v[128:143], v[204:207], v[28:31], v[128:143]
  s_waitcnt lgkmcnt(4)
  ds_read_b64_tr_b16 v[196:197], v249 offset:16384
  ds_read_b64_tr_b16 v[198:199], v249 offset:16896
  v_mfma_f32_32x32x16_bf16 v[128:143], v[208:211], v[32:35], v[128:143]
  ds_read_b64_tr_b16 v[200:201], v249 offset:18432
  ds_read_b64_tr_b16 v[202:203], v249 offset:18944
  v_mfma_f32_32x32x16_bf16 v[128:143], v[212:215], v[36:39], v[128:143]
  s_waitcnt lgkmcnt(4)
  ds_read_b64_tr_b16 v[204:205], v249 offset:20480
  ds_read_b64_tr_b16 v[206:207], v249 offset:20992
  v_mfma_f32_32x32x16_bf16 v[128:143], v[216:219], v[40:43], v[128:143]
  ds_read_b64_tr_b16 v[208:209], v249 offset:22528
  ds_read_b64_tr_b16 v[210:211], v249 offset:23040
  v_mfma_f32_32x32x16_bf16 v[128:143], v[192:195], v[44:47], v[128:143]
  s_waitcnt lgkmcnt(4)
  ds_read_b64_tr_b16 v[212:213], v249 offset:24576
  ds_read_b64_tr_b16 v[214:215], v249 offset:25088
  v_mfma_f32_32x32x16_bf16 v[128:143], v[196:199], v[48:51], v[128:143]
  s_waitcnt vmcnt(0)
  v_mov_b32 v3, 155648
  v_mov_b32 v4, 1
  s_mov_b64 exec, 1
  ds_add_u32 v3, v4 offset:0
  s_mov_b64 exec, -1
  ds_read_b64_tr_b16 v[216:217], v249 offset:26624
  ds_read_b64_tr_b16 v[218:219], v249 offset:27136
  v_mfma_f32_32x32x16_bf16 v[128:143], v[200:203], v[52:55], v[128:143]
  s_waitcnt lgkmcnt(5)
  ds_read_b64_tr_b16 v[192:193], v249 offset:28672
  ds_read_b64_tr_b16 v[194:195], v249 offset:29184
  v_mfma_f32_32x32x16_bf16 v[128:143], v[204:207], v[56:59], v[128:143]
  ds_read_b64_tr_b16 v[196:197], v249 offset:30720
  ds_read_b64_tr_b16 v[198:199], v249 offset:31232
  v_mfma_f32_32x32x16_bf16 v[128:143], v[208:211], v[60:63], v[128:143]
  s_waitcnt lgkmcnt(4)
  v_mov_b32 v3, 155648
  s_mov_b32 s66, 1048576
LP_f5168:
  ds_read_b32 v4, v3 offset:0
  s_sub_u32 s66, s66, 1
  s_waitcnt lgkmcnt(0)
  v_readfirstlane_b32 s3, v4
  s_nop 0
  s_cmp_lt_u32 s3, 1032
  s_cselect_b32 s3, s66, 0
  s_cmp_lg_u32 s3, 0
  s_cbranch_scc1 LP_f5168
  ds_read_b64_tr_b16 v[200:201], v249 offset:32768
  ds_read_b64_tr_b16 v[202:203], v249 offset:33280
  v_mfma_f32_32x32x16_bf16 v[128:143], v[212:215], v[64:67], v[128:143]
  ds_read_b64_tr_b16 v[204:205], v249 offset:34816
  ds_read_b64_tr_b16 v[206:207], v249 offset:35328
  v_mfma_f32_32x32x16_bf16 v[128:143], v[216:219], v[68:71], v[128:143]
  ds_read_b64_tr_b16 v[208:209], v249 offset:36864
  ds_read_b64_tr_b16 v[210:211], v249 offset:37376
  v_mfma_f32_32x32x16_bf16 v[128:143], v[192:195], v[72:75], v[128:143]
  ds_read_b64_tr_b16 v[212:213], v249 offset:38912
  ds_read_b64_tr_b16 v[214:215], v249 offset:39424
  v_mfma_f32_32x32x16_bf16 v[128:143], v[196:199], v[76:79], v[128:143]
  s_waitcnt lgkmcnt(4)
  ds_read_b64_tr_b16 v[216:217], v249 offset:40960
  ds_read_b64_tr_b16 v[218:219], v249 offset:41472
  v_mfma_f32_32x32x16_bf16 v[128:143], v[200:203], v[80:83], v[128:143]
  ds_read_b64_tr_b16 v[192:193], v249 offset:43008
  ds_read_b64_tr_b16 v[194:195], v249 offset:43520
  v_mfma_f32_32x32x16_bf16 v[128:143], v[204:207], v[84:87], v[128:143]
  s_waitcnt lgkmcnt(4)
  ds_read_b64_tr_b16 v[196:197], v249 offset:45056
  ds_read_b64_tr_b16 v[198:199], v249 offset:45568
  v_mfma_f32_32x32x16_bf16 v[128:143], v[208:211], v[88:91], v[128:143]
  ds_read_b64_tr_b16 v[200:201], v249 offset:47104
  ds_read_b64_tr_b16 v[202:203], v249 offset:47616
  v_mfma_f32_32x32x16_bf16 v[128:143], v[212:215], v[92:95], v[128:143]
  s_waitcnt lgkmcnt(4)
  ds_read_b64_tr_b16 v[204:205], v249 offset:49152
  ds_read_b64_tr_b16 v[206:207], v249 offset:49664
  v_mfma_f32_32x32x16_bf16 v[128:143], v[216:219], v[96:99], v[128:143]
  ds_read_b64_tr_b16 v[208:209], v249 offset:51200
  ds_read_b64_tr_b16 v[210:211], v249 offset:51712
  v_mfma_f32_32x32x16_bf16 v[128:143], v[192:195], v[100:103], v[128:143]
  s_waitcnt lgkmcnt(4)
  ds_read_b64_tr_b16 v[212:213], v249 offset:53248
  ds_read_b64_tr_b16 v[214:215], v249 offset:53760
  v_mfma_f32_32x32x16_bf16 v[128:143], v[196:199], v[104:107], v[128:143]
  ds_read_b64_tr_b16 v[216:217], v249 offset:55296
  ds_read_b64_tr_b16 v[218:219], v249 offset:55808
  v_mfma_f32_32x32x16_bf16 v[128:143], v[200:203], v[108:111], v[128:143]
  s_waitcnt lgkmcnt(4)
  ds_read_b64_tr_b16 v[192:193], v250 offset:0
  ds_read_b64_tr_b16 v[194:195], v250 offset:512
  v_mfma_f32_32x32x16_bf16 v[128:143], v[204:207], v[112:115], v[128:143]
  ds_read_b64_tr_b16 v[196:197], v250 offset:2048
  ds_read_b64_tr_b16 v[198:199], v250 offset:2560
  v_mfma_f32_32x32x16_bf16 v[128:143], v[208:211], v[116:119], v[128:143]
  s_waitcnt lgkmcnt(4)
  ds_read_b64_tr_b16 v[200:201], v250 offset:4096
  ds_read_b64_tr_b16 v[202:203], v250 offset:4608
  v_mfma_f32_32x32x16_bf16 v[128:143], v[212:215], v[120:123], v[128:143]
  ds_read_b64_tr_b16 v[204:205], v250 offset:6144
  ds_read_b64_tr_b16 v[206:207], v250 offset:6656
  v_mfma_f32_32x32x16_bf16 v[128:143], v[216:219], v[124:127], v[128:143]
  s_waitcnt lgkmcnt(4)
  ds_read_b64_tr_b16 v[208:209], v250 offset:8192
  ds_read_b64_tr_b16 v[210:211], v250 offset:8704
  v_mfma_f32_32x32x16_bf16 v[144:159], v[192:195], v[16:19], v[144:159]
  ds_read_b64_tr_b16 v[212:213], v250 offset:10240
  ds_read_b64_tr_b16 v[214:215], v250 offset:10752
  v_mfma_f32_32x32x16_bf16 v[144:159], v[196:199], v[20:23], v[144:159]
  s_waitcnt lgkmcnt(4)
  ds_read_b64_tr_b16 v[216:217], v250 offset:12288
  ds_read_b64_tr_b16 v[218:219], v250 offset:12800
  v_mfma_f32_32x32x16_bf16 v[144:159], v[200:203], v[24:27], v[144:159]
  ds_read_b64_tr_b16 v[192:193], v250 offset:14336
  ds_read_b64_tr_b16 v[194:195], v250 offset:14848
  v_mul_f32 v220, 0x3fb8aa3b, v128
  v_mul_f32 v221, 0x3fb8aa3b, v129
  v_mul_f32 v222, 0x3fb8aa3b, v130
  v_mul_f32 v223, 0x3fb8aa3b, v131
  v_exp_f32 v220, v220
  v_mfma_f32_32x32x16_bf16 v[144:159], v[204:207], v[28:31], v[144:159]
  s_waitcnt lgkmcnt(4)
  ds_read_b64_tr_b16 v[196:197], v250 offset:16384
  ds_read_b64_tr_b16 v[198:199], v250 offset:16896
  v_exp_f32 v221, v221
  v_exp_f32 v222, v222
  v_exp_f32 v223, v223
  v_fma_f32 v224, v220, 0.5, 1.0
  v_mfma_f32_32x32x16_bf16 v[144:159], v[208:211], v[32:35], v[144:159]
  ds_read_b64_tr_b16 v[200:201], v250 offset:18432
  ds_read_b64_tr_b16 v[202:203], v250 offset:18944
  v_fma_f32 v225, v221, 0.5, 1.0
  v_fma_f32 v226, v222, 0.5, 1.0
  v_fma_f32 v227, v223, 0.5, 1.0
  v_fma_f32 v220, v220, v224, 1.0
  v_mfma_f32_32x32x16_bf16 v[144:159], v[212:215], v[36:39], v[144:159]
  s_waitcnt lgkmcnt(4)
  ds_read_b64_tr_b16 v[204:205], v250 offset:20480
  ds_read_b64_tr_b16 v[206:207], v250 offset:20992
  v_fma_f32 v221, v221, v225, 1.0
  v_fma_f32 v222, v222, v226, 1.0
  v_fma_f32 v223, v223, v227, 1.0
  v_rcp_f32 v220, v220
  v_rcp_f32 v221, v221
  v_mfma_f32_32x32x16_bf16 v[144:159], v[216:219], v[40:43], v[144:159]
  ds_read_b64_tr_b16 v[208:209], v250 offset:22528
  ds_read_b64_tr_b16 v[210:211], v250 offset:23040
  v_rcp_f32 v222, v222
  v_rcp_f32 v223, v223
  v_fma_f32 v128, -v128, v220, v128
  v_fma_f32 v129, -v129, v221, v129
  v_mfma_f32_32x32x16_bf16 v[144:159], v[192:195], v[44:47], v[144:159]
  s_waitcnt lgkmcnt(4)
  ds_read_b64_tr_b16 v[212:213], v250 offset:24576
  ds_read_b64_tr_b16 v[214:215], v250 offset:25088
  v_fma_f32 v130, -v130, v222, v130
  v_fma_f32 v131, -v131, v223, v131
  v_cvt_pk_bf16_f32 v128, v128, v129
  v_cvt_pk_bf16_f32 v129, v130, v131
  v_mfma_f32_32x32x16_bf16 v[144:159], v[196:199], v[48:51], v[144:159]
  ds_read_b64_tr_b16 v[216:217], v250 offset:26624
  ds_read_b64_tr_b16 v[218:219], v250 offset:27136
  v_mul_f32 v220, 0x3fb8aa3b, v132
  v_mul_f32 v221, 0x3fb8aa3b, v133
  v_mul_f32 v222, 0x3fb8aa3b, v134
  v_mul_f32 v223, 0x3fb8aa3b, v135
  v_exp_f32 v220, v220
  v_mfma_f32_32x32x16_bf16 v[144:159], v[200:203], v[52:55], v[144:159]
  s_waitcnt lgkmcnt(4)
  ds_read_b64_tr_b16 v[192:193], v250 offset:28672
  ds_read_b64_tr_b16 v[194:195], v250 offset:29184
  v_exp_f32 v221, v221
  v_exp_f32 v222, v222
  v_exp_f32 v223, v223
  v_fma_f32 v224, v220, 0.5, 1.0
  v_mfma_f32_32x32x16_bf16 v[144:159], v[204:207], v[56:59], v[144:159]
  ds_read_b64_tr_b16 v[196:197], v250 offset:30720
  ds_read_b64_tr_b16 v[198:199], v250 offset:31232
  v_fma_f32 v225, v221, 0.5, 1.0
  v_fma_f32 v226, v222, 0.5, 1.0
  v_fma_f32 v227, v223, 0.5, 1.0
  v_fma_f32 v220, v220, v224, 1.0
  v_mfma_f32_32x32x16_bf16 v[144:159], v[208:211], v[60:63], v[144:159]
  s_waitcnt lgkmcnt(4)
  ds_read_b64_tr_b16 v[200:201], v250 offset:32768
  ds_read_b64_tr_b16 v[202:203], v250 offset:33280
  v_fma_f32 v221, v221, v225, 1.0
  v_fma_f32 v222, v222, v226, 1.0
  v_fma_f32 v223, v223, v227, 1.0
  v_rcp_f32 v220, v220
  v_rcp_f32 v221, v221
  v_mfma_f32_32x32x16_bf16 v[144:159], v[212:215], v[64:67], v[144:159]
  ds_read_b64_tr_b16 v[204:205], v250 offset:34816
  ds_read_b64_tr_b16 v[206:207], v250 offset:35328
  v_rcp_f32 v222, v222
  v_rcp_f32 v223, v223
  v_fma_f32 v132, -v132, v220, v132
  v_fma_f32 v133, -v133, v221, v133
  v_mfma_f32_32x32x16_bf16 v[144:159], v[216:219], v[68:71], v[144:159]
  s_waitcnt lgkmcnt(4)
  ds_read_b64_tr_b16 v[208:209], v250 offset:36864
  ds_read_b64_tr_b16 v[210:211], v250 offset:37376
  v_fma_f32 v134, -v134, v222, v134
  v_fma_f32 v135, -v135, v223, v135
  v_cvt_pk_bf16_f32 v130, v132, v133
  v_cvt_pk_bf16_f32 v131, v134, v135
  v_mfma_f32_32x32x16_bf16 v[144:159], v[192:195], v[72:75], v[144:159]
  ds_read_b64_tr_b16 v[212:213], v250 offset:38912
  ds_read_b64_tr_b16 v[214:215], v250 offset:39424
  v_mul_f32 v220, 0x3fb8aa3b, v136
  v_mul_f32 v221, 0x3fb8aa3b, v137
  v_mul_f32 v222, 0x3fb8aa3b, v138
  v_mul_f32 v223, 0x3fb8aa3b, v139
  v_exp_f32 v220, v220
  v_mfma_f32_32x32x16_bf16 v[144:159], v[196:199], v[76:79], v[144:159]
  s_waitcnt lgkmcnt(4)
  ds_read_b64_tr_b16 v[216:217], v250 offset:40960
  ds_read_b64_tr_b16 v[218:219], v250 offset:41472
  v_exp_f32 v221, v221
  v_exp_f32 v222, v222
  v_exp_f32 v223, v223
  v_fma_f32 v224, v220, 0.5, 1.0
  v_mfma_f32_32x32x16_bf16 v[144:159], v[200:203], v[80:83], v[144:159]
  ds_read_b64_tr_b16 v[192:193], v250 offset:43008
  ds_read_b64_tr_b16 v[194:195], v250 offset:43520
  v_fma_f32 v225, v221, 0.5, 1.0
  v_fma_f32 v226, v222, 0.5, 1.0
  v_fma_f32 v227, v223, 0.5, 1.0
  v_fma_f32 v220, v220, v224, 1.0
  v_mfma_f32_32x32x16_bf16 v[144:159], v[204:207], v[84:87], v[144:159]
  s_waitcnt lgkmcnt(4)
  ds_read_b64_tr_b16 v[196:197], v250 offset:45056
  ds_read_b64_tr_b16 v[198:199], v250 offset:45568
  v_fma_f32 v221, v221, v225, 1.0
  v_fma_f32 v222, v222, v226, 1.0
  v_fma_f32 v223, v223, v227, 1.0
  v_rcp_f32 v220, v220
  v_rcp_f32 v221, v221
  v_mfma_f32_32x32x16_bf16 v[144:159], v[208:211], v[88:91], v[144:159]
  ds_read_b64_tr_b16 v[200:201], v250 offset:47104
  ds_read_b64_tr_b16 v[202:203], v250 offset:47616
  v_rcp_f32 v222, v222
  v_rcp_f32 v223, v223
  v_fma_f32 v136, -v136, v220, v136
  v_fma_f32 v137, -v137, v221, v137
  v_mfma_f32_32x32x16_bf16 v[144:159], v[212:215], v[92:95], v[144:159]
  s_waitcnt lgkmcnt(4)
  ds_read_b64_tr_b16 v[204:205], v250 offset:49152
  ds_read_b64_tr_b16 v[206:207], v250 offset:49664
  v_fma_f32 v138, -v138, v222, v138
  v_fma_f32 v139, -v139, v223, v139
  v_cvt_pk_bf16_f32 v132, v136, v137
  v_cvt_pk_bf16_f32 v133, v138, v139
  v_mfma_f32_32x32x16_bf16 v[144:159], v[216:219], v[96:99], v[144:159]
  ds_read_b64_tr_b16 v[208:209], v250 offset:51200
  ds_read_b64_tr_b16 v[210:211], v250 offset:51712
  v_mul_f32 v220, 0x3fb8aa3b, v140
  v_mul_f32 v221, 0x3fb8aa3b, v141
  v_mul_f32 v222, 0x3fb8aa3b, v142
  v_mul_f32 v223, 0x3fb8aa3b, v143
  v_exp_f32 v220, v220
  v_mfma_f32_32x32x16_bf16 v[144:159], v[192:195], v[100:103], v[144:159]
  s_waitcnt lgkmcnt(4)
  ds_read_b64_tr_b16 v[212:213], v250 offset:53248
  ds_read_b64_tr_b16 v[214:215], v250 offset:53760
  v_exp_f32 v221, v221
  v_exp_f32 v222, v222
  v_exp_f32 v223, v223
  v_fma_f32 v224, v220, 0.5, 1.0
  v_mfma_f32_32x32x16_bf16 v[144:159], v[196:199], v[104:107], v[144:159]
  ds_read_b64_tr_b16 v[216:217], v250 offset:55296
  ds_read_b64_tr_b16 v[218:219], v250 offset:55808
  v_fma_f32 v225, v221, 0.5, 1.0
  v_fma_f32 v226, v222, 0.5, 1.0
  v_fma_f32 v227, v223, 0.5, 1.0
  v_fma_f32 v220, v220, v224, 1.0
  v_mfma_f32_32x32x16_bf16 v[144:159], v[200:203], v[108:111], v[144:159]
  s_waitcnt lgkmcnt(4)
  v_fma_f32 v221, v221, v225, 1.0
  v_fma_f32 v222, v222, v226, 1.0
  v_fma_f32 v223, v223, v227, 1.0
  v_rcp_f32 v220, v220
  v_rcp_f32 v221, v221
  v_mfma_f32_32x32x16_bf16 v[144:159], v[204:207], v[112:115], v[144:159]
  v_rcp_f32 v222, v222
  v_rcp_f32 v223, v223
  v_fma_f32 v140, -v140, v220, v140
  v_fma_f32 v141, -v141, v221, v141
  v_mfma_f32_32x32x16_bf16 v[144:159], v[208:211], v[116:119], v[144:159]
  s_waitcnt lgkmcnt(0)
  v_fma_f32 v142, -v142, v222, v142
  v_fma_f32 v143, -v143, v223, v143
  v_cvt_pk_bf16_f32 v134, v140, v141
  v_cvt_pk_bf16_f32 v135, v142, v143
  v_mfma_f32_32x32x16_bf16 v[144:159], v[212:215], v[120:123], v[144:159]
  v_mfma_f32_32x32x16_bf16 v[144:159], v[216:219], v[124:127], v[144:159]
  s_mov_b32 s68, 0x3fb8aa3b
  s_mov_b32 s69, 0x3fb8aa3b
  s_nop 9
  v_pk_mul_f32 v[220:221], v[144:145], s[68:69]
  v_pk_mul_f32 v[222:223], v[146:147], s[68:69]
  v_exp_f32 v220, v220
  v_exp_f32 v221, v221
  v_exp_f32 v222, v222
  v_exp_f32 v223, v223
  v_pk_fma_f32 v[224:225], v[220:221], 0.5, 1.0 op_sel_hi:[1,0,0]
  v_pk_fma_f32 v[226:227], v[222:223], 0.5, 1.0 op_sel_hi:[1,0,0]
  v_pk_fma_f32 v[220:221], v[220:221], v[224:225], 1.0 op_sel_hi:[1,1,0]
  v_pk_fma_f32 v[222:223], v[222:223], v[226:227], 1.0 op_sel_hi:[1,1,0]
  v_rcp_f32 v220, v220
  v_rcp_f32 v221, v221
  v_rcp_f32 v222, v222
  v_rcp_f32 v223, v223
  v_pk_fma_f32 v[144:145], v[144:145], v[220:221], v[144:145] neg_lo:[1,0,0] neg_hi:[1,0,0]
  v_pk_fma_f32 v[146:147], v[146:147], v[222:223], v[146:147] neg_lo:[1,0,0] neg_hi:[1,0,0]
  v_cvt_pk_bf16_f32 v144, v144, v145
  v_cvt_pk_bf16_f32 v145, v146, v147
  v_pk_mul_f32 v[220:221], v[148:149], s[68:69]
  v_pk_mul_f32 v[222:223], v[150:151], s[68:69]
  v_exp_f32 v220, v220
  v_exp_f32 v221, v221
  v_exp_f32 v222, v222
  v_exp_f32 v223, v223
  v_pk_fma_f32 v[224:225], v[220:221], 0.5, 1.0 op_sel_hi:[1,0,0]
  v_pk_fma_f32 v[226:227], v[222:223], 0.5, 1.0 op_sel_hi:[1,0,0]
  v_pk_fma_f32 v[220:221], v[220:221], v[224:225], 1.0 op_sel_hi:[1,1,0]
  v_pk_fma_f32 v[222:223], v[222:223], v[226:227], 1.0 op_sel_hi:[1,1,0]
  v_rcp_f32 v220, v220
  v_rcp_f32 v221, v221
  v_rcp_f32 v222, v222
  v_rcp_f32 v223, v223
  v_pk_fma_f32 v[148:149], v[148:149], v[220:221], v[148:149] neg_lo:[1,0,0] neg_hi:[1,0,0]
  v_pk_fma_f32 v[150:151], v[150:151], v[222:223], v[150:151] neg_lo:[1,0,0] neg_hi:[1,0,0]
  v_cvt_pk_bf16_f32 v146, v148, v149
  v_cvt_pk_bf16_f32 v147, v150, v151
  v_pk_mul_f32 v[220:221], v[152:153], s[68:69]
  v_pk_mul_f32 v[222:223], v[154:155], s[68:69]
  v_exp_f32 v220, v220
  v_exp_f32 v221, v221
  v_exp_f32 v222, v222
  v_exp_f32 v223, v223
  v_pk_fma_f32 v[224:225], v[220:221], 0.5, 1.0 op_sel_hi:[1,0,0]
  v_pk_fma_f32 v[226:227], v[222:223], 0.5, 1.0 op_sel_hi:[1,0,0]
  v_pk_fma_f32 v[220:221], v[220:221], v[224:225], 1.0 op_sel_hi:[1,1,0]
  v_pk_fma_f32 v[222:223], v[222:223], v[226:227], 1.0 op_sel_hi:[1,1,0]
  v_rcp_f32 v220, v220
  v_rcp_f32 v221, v221
  v_rcp_f32 v222, v222
  v_rcp_f32 v223, v223
  v_pk_fma_f32 v[152:153], v[152:153], v[220:221], v[152:153] neg_lo:[1,0,0] neg_hi:[1,0,0]
  v_pk_fma_f32 v[154:155], v[154:155], v[222:223], v[154:155] neg_lo:[1,0,0] neg_hi:[1,0,0]
  v_cvt_pk_bf16_f32 v148, v152, v153
  v_cvt_pk_bf16_f32 v149, v154, v155
  v_pk_mul_f32 v[220:221], v[156:157], s[68:69]
  v_pk_mul_f32 v[222:223], v[158:159], s[68:69]
  v_exp_f32 v220, v220
  v_exp_f32 v221, v221
  v_exp_f32 v222, v222
  v_exp_f32 v223, v223
  v_pk_fma_f32 v[224:225], v[220:221], 0.5, 1.0 op_sel_hi:[1,0,0]
  v_pk_fma_f32 v[226:227], v[222:223], 0.5, 1.0 op_sel_hi:[1,0,0]
  v_pk_fma_f32 v[220:221], v[220:221], v[224:225], 1.0 op_sel_hi:[1,1,0]
  v_pk_fma_f32 v[222:223], v[222:223], v[226:227], 1.0 op_sel_hi:[1,1,0]
  v_rcp_f32 v220, v220
  v_rcp_f32 v221, v221
  v_rcp_f32 v222, v222
  v_rcp_f32 v223, v223
  v_pk_fma_f32 v[156:157], v[156:157], v[220:221], v[156:157] neg_lo:[1,0,0] neg_hi:[1,0,0]
  v_pk_fma_f32 v[158:159], v[158:159], v[222:223], v[158:159] neg_lo:[1,0,0] neg_hi:[1,0,0]
  v_cvt_pk_bf16_f32 v150, v156, v157
  v_cvt_pk_bf16_f32 v151, v158, v159
  s_branch EN_f5166
EL_f5165:
  s_waitcnt lgkmcnt(0)
  v_mov_b32 v3, 155648
  v_mov_b32 v4, 2
  s_mov_b64 exec, 1
  ds_add_u32 v3, v4 offset:0
  s_mov_b64 exec, -1
  s_cmp_eq_u32 s54, 3
  s_cbranch_scc0 EL_f5169
  ds_read_b128 v[192:195], v9 offset:0
  ds_read_b128 v[196:199], v9 offset:32
  ds_read_b128 v[200:203], v9 offset:64
  ds_read_b128 v[204:207], v9 offset:96
  s_waitcnt lgkmcnt(3)
  v_mfma_f32_32x32x16_bf16 v[128:143], v[192:195], v[16:19], 0
  ds_read_b128 v[208:211], v9 offset:128
  s_waitcnt lgkmcnt(3)
  v_mfma_f32_32x32x16_bf16 v[128:143], v[196:199], v[20:23], v[128:143]
  ds_read_b128 v[212:215], v9 offset:160
  s_waitcnt lgkmcnt(3)
  v_mfma_f32_32x32x16_bf16 v[128:143], v[200:203], v[24:27], v[128:143]
  ds_read_b128 v[192:195], v9 offset:192
  s_waitcnt lgkmcnt(3)
  v_mfma_f32_32x32x16_bf16 v[128:143], v[204:207], v[28:31], v[128:143]
  ds_read_b128 v[196:199], v9 offset:224
  s_waitcnt lgkmcnt(3)
  v_mfma_f32_32x32x16_bf16 v[128:143], v[208:211], v[32:35], v[128:143]
  ds_read_b128 v[200:203], v9 offset:256
  s_waitcnt lgkmcnt(3)
  v_mfma_f32_32x32x16_bf16 v[128:143], v[212:215], v[36:39], v[128:143]
  ds_read_b128 v[204:207], v9 offset:288
  s_waitcnt lgkmcnt(3)
  v_mfma_f32_32x32x16_bf16 v[128:143], v[192:195], v[40:43], v[128:143]
  ds_read_b128 v[208:211], v9 offset:320
  s_waitcnt lgkmcnt(3)
  v_mfma_f32_32x32x16_bf16 v[128:143], v[196:199], v[44:47], v[128:143]
  ds_read_b128 v[212:215], v9 offset:352
  s_waitcnt lgkmcnt(3)
  v_mfma_f32_32x32x16_bf16 v[128:143], v[200:203], v[48:51], v[128:143]
  ds_read_b128 v[192:195], v9 offset:384
  s_waitcnt lgkmcnt(3)
  v_mfma_f32_32x32x16_bf16 v[128:143], v[204:207], v[52:55], v[128:143]
  ds_read_b128 v[196:199], v9 offset:416
  s_waitcnt lgkmcnt(3)
  v_mfma_f32_32x32x16_bf16 v[128:143], v[208:211], v[56:59], v[128:143]
  ds_read_b128 v[200:203], v9 offset:448
  s_waitcnt lgkmcnt(3)
  v_mfma_f32_32x32x16_bf16 v[128:143], v[212:215], v[60:63], v[128:143]
  ds_read_b128 v[204:207], v9 offset:480
  s_waitcnt lgkmcnt(3)
  v_mfma_f32_32x32x16_bf16 v[128:143], v[192:195], v[64:67], v[128:143]
  ds_read_b128 v[208:211], v9 offset:512
  s_waitcnt lgkmcnt(3)
  v_mfma_f32_32x32x16_bf16 v[128:143], v[196:199], v[68:71], v[128:143]
  ds_read_b128 v[212:215], v9 offset:544
  s_waitcnt lgkmcnt(3)
  v_mfma_f32_32x32x16_bf16 v[128:143], v[200:203], v[72:75], v[128:143]
  ds_read_b128 v[192:195], v9 offset:576
  s_waitcnt lgkmcnt(3)
  v_mfma_f32_32x32x16_bf16 v[128:143], v[204:207], v[76:79], v[128:143]
  ds_read_b128 v[196:199], v9 offset:608
  s_waitcnt lgkmcnt(3)
  v_mfma_f32_32x32x16_bf16 v[128:143], v[208:211], v[80:83], v[128:143]
  ds_read_b128 v[200:203], v9 offset:640
  s_waitcnt lgkmcnt(3)
  v_mfma_f32_32x32x16_bf16 v[128:143], v[212:215], v[84:87], v[128:143]
  ds_read_b128 v[204:207], v9 offset:672
  s_waitcnt lgkmcnt(3)
  v_mfma_f32_32x32x16_bf16 v[128:143], v[192:195], v[88:91], v[128:143]
  ds_read_b128 v[208:211], v9 offset:704
  s_waitcnt lgkmcnt(3)
  v_mfma_f32_32x32x16_bf16 v[128:143], v[196:199], v[92:95], v[128:143]
  ds_read_b128 v[212:215], v9 offset:736
  s_waitcnt lgkmcnt(3)
  v_mfma_f32_32x32x16_bf16 v[128:143], v[200:203], v[96:99], v[128:143]
  ds_read_b128 v[192:195], v9 offset:768
  s_waitcnt lgkmcnt(3)
  v_mfma_f32_32x32x16_bf16 v[128:143], v[204:207], v[100:103], v[128:143]
  ds_read_b128 v[196:199], v9 offset:800
  s_waitcnt lgkmcnt(3)
  v_mfma_f32_32x32x16_bf16 v[128:143], v[208:211], v[104:107], v[128:143]
  ds_read_b128 v[200:203], v9 offset:832
  s_waitcnt lgkmcnt(3)
  v_mfma_f32_32x32x16_bf16 v[128:143], v[212:215], v[108:111], v[128:143]
  ds_read_b128 v[204:207], v9 offset:864
  s_waitcnt lgkmcnt(3)
  v_mfma_f32_32x32x16_bf16 v[128:143], v[192:195], v[112:115], v[128:143]
  s_waitcnt lgkmcnt(2)
  v_mfma_f32_32x32x16_bf16 v[128:143], v[196:199], v[116:119], v[128:143]
  s_waitcnt lgkmcnt(1)
  v_mfma_f32_32x32x16_bf16 v[128:143], v[200:203], v[120:123], v[128:143]
  s_waitcnt lgkmcnt(0)
  v_mfma_f32_32x32x16_bf16 v[128:143], v[204:207], v[124:127], v[128:143]
  s_nop 11
  v_mul_f32 v128, 0xbfb8aa3b, v128
  v_exp_f32 v128, v128
  s_nop 0
  v_add_f32 v128, 1.0, v128
  v_rcp_f32 v128, v128
  v_and_b32 v129, 31, v1
  v_lshlrev_b32 v129, 2, v129
EL_f5169:
EN_f5166:
  v_subrev_u32 v249, 65536, v249
  v_subrev_u32 v250, 65536, v250
  v_mov_b32 v3, 155648
  s_setprio 0
  s_mov_b32 s66, 1048576
LP_f5171:
  ds_read_b32 v4, v3 offset:4
  s_sub_u32 s66, s66, 1
  s_waitcnt lgkmcnt(0)
  v_readfirstlane_b32 s3, v4
  s_nop 0
  s_and_b32 s3, s3, 255
  s_cmp_lt_u32 s3, 4
  s_cselect_b32 s3, s66, 0
  s_cmp_lg_u32 s3, 0
  s_cbranch_scc1 LP_f5171
  s_setprio 2
  ds_read_b64_tr_b16 v[192:193], v249 offset:0
  ds_read_b64_tr_b16 v[194:195], v249 offset:512
  ds_read_b64_tr_b16 v[196:197], v249 offset:2048
  ds_read_b64_tr_b16 v[198:199], v249 offset:2560
  ds_read_b64_tr_b16 v[200:201], v249 offset:4096
  ds_read_b64_tr_b16 v[202:203], v249 offset:4608
  ds_read_b64_tr_b16 v[204:205], v249 offset:6144
  ds_read_b64_tr_b16 v[206:207], v249 offset:6656
  ds_read_b64_tr_b16 v[208:209], v249 offset:8192
  ds_read_b64_tr_b16 v[210:211], v249 offset:8704
  s_waitcnt lgkmcnt(8)
  v_mfma_f32_32x32x16_bf16 v[160:175], v[192:195], v[16:19], v[160:175]
  ds_read_b64_tr_b16 v[212:213], v249 offset:10240
  ds_read_b64_tr_b16 v[214:215], v249 offset:10752
  s_waitcnt lgkmcnt(8)
  v_mfma_f32_32x32x16_bf16 v[160:175], v[196:199], v[20:23], v[160:175]
  s_waitcnt lgkmcnt(4)
  ds_read_b64_tr_b16 v[216:217], v249 offset:12288
  ds_read_b64_tr_b16 v[218:219], v249 offset:12800
  v_mfma_f32_32x32x16_bf16 v[160:175], v[200:203], v[24:27], v[160:175]
  ds_read_b64_tr_b16 v[192:193], v249 offset:14336
  ds_read_b64_tr_b16 v[194:195], v249 offset:14848
  v_mfma_f32_32x32x16_bf16 v[160:175], v[204:207], v[28:31], v[160:175]
  s_waitcnt lgkmcnt(4)
  ds_read_b64_tr_b16 v[196:197], v249 offset:16384
  ds_read_b64_tr_b16 v[198:199], v249 offset:16896
  v_mfma_f32_32x32x16_bf16 v[160:175], v[208:211], v[32:35], v[160:175]
  ds_read_b64_tr_b16 v[200:201], v249 offset:18432
  ds_read_b64_tr_b16 v[202:203], v249 offset:18944
  v_mfma_f32_32x32x16_bf16 v[160:175], v[212:215], v[36:39], v[160:175]
  s_waitcnt lgkmcnt(4)
  ds_read_b64_tr_b16 v[204:205], v249 offset:20480
  ds_read_b64_tr_b16 v[206:207], v249 offset:20992
  v_mfma_f32_32x32x16_bf16 v[160:175], v[216:219], v[40:43], v[160:175]
  ds_read_b64_tr_b16 v[208:209], v249 offset:22528
  ds_read_b64_tr_b16 v[210:211], v249 offset:23040
  v_mfma_f32_32x32x16_bf16 v[160:175], v[192:195], v[44:47], v[160:175]
  s_waitcnt lgkmcnt(4)
  ds_read_b64_tr_b16 v[212:213], v249 offset:24576
  ds_read_b64_tr_b16 v[214:215], v249 offset:25088
  v_mfma_f32_32x32x16_bf16 v[160:175], v[196:199], v[48:51], v[160:175]
  ds_read_b64_tr_b16 v[216:217], v249 offset:26624
  ds_read_b64_tr_b16 v[218:219], v249 offset:27136
  v_mfma_f32_32x32x16_bf16 v[160:175], v[200:203], v[52:55], v[160:175]
  s_waitcnt lgkmcnt(4)
  ds_read_b64_tr_b16 v[192:193], v249 offset:28672
  ds_read_b64_tr_b16 v[194:195], v249 offset:29184
  v_mfma_f32_32x32x16_bf16 v[160:175], v[204:207], v[56:59], v[160:175]
  ds_read_b64_tr_b16 v[196:197], v249 offset:30720
  ds_read_b64_tr_b16 v[198:199], v249 offset:31232
  v_mfma_f32_32x32x16_bf16 v[160:175], v[208:211], v[60:63], v[160:175]
  s_waitcnt lgkmcnt(4)
  v_mov_b32 v3, 155648
  s_mov_b32 s66, 1048576
LP_f5172:
  ds_read_b32 v4, v3 offset:4
  s_sub_u32 s66, s66, 1
  s_waitcnt lgkmcnt(0)
  v_readfirstlane_b32 s3, v4
  s_nop 0
  s_and_b32 s3, s3, 65280
  s_cmp_lt_u32 s3, 1024
  s_cselect_b32 s3, s66, 0
  s_cmp_lg_u32 s3, 0
  s_cbranch_scc1 LP_f5172
  ds_read_b64_tr_b16 v[200:201], v249 offset:32768
  ds_read_b64_tr_b16 v[202:203], v249 offset:33280
  v_mfma_f32_32x32x16_bf16 v[160:175], v[212:215], v[64:67], v[160:175]
  ds_read_b64_tr_b16 v[204:205], v249 offset:34816
  ds_read_b64_tr_b16 v[206:207], v249 offset:35328
  v_mfma_f32_32x32x16_bf16 v[160:175], v[216:219], v[68:71], v[160:175]
  ds_read_b64_tr_b16 v[208:209], v249 offset:36864
  ds_read_b64_tr_b16 v[210:211], v249 offset:37376
  v_mfma_f32_32x32x16_bf16 v[160:175], v[192:195], v[72:75], v[160:175]
  ds_read_b64_tr_b16 v[212:213], v249 offset:38912
  ds_read_b64_tr_b16 v[214:215], v249 offset:39424
  v_mfma_f32_32x32x16_bf16 v[160:175], v[196:199], v[76:79], v[160:175]
  s_waitcnt lgkmcnt(4)
  ds_read_b64_tr_b16 v[216:217], v249 offset:40960
  ds_read_b64_tr_b16 v[218:219], v249 offset:41472
  v_mfma_f32_32x32x16_bf16 v[160:175], v[200:203], v[80:83], v[160:175]
  ds_read_b64_tr_b16 v[192:193], v249 offset:43008
  ds_read_b64_tr_b16 v[194:195], v249 offset:43520
  v_mfma_f32_32x32x16_bf16 v[160:175], v[204:207], v[84:87], v[160:175]
  s_waitcnt lgkmcnt(4)
  ds_read_b64_tr_b16 v[196:197], v249 offset:45056
  ds_read_b64_tr_b16 v[198:199], v249 offset:45568
  v_mfma_f32_32x32x16_bf16 v[160:175], v[208:211], v[88:91], v[160:175]
  ds_read_b64_tr_b16 v[200:201], v249 offset:47104
  ds_read_b64_tr_b16 v[202:203], v249 offset:47616
  v_mfma_f32_32x32x16_bf16 v[160:175], v[212:215], v[92:95], v[160:175]
  s_waitcnt lgkmcnt(4)
  ds_read_b64_tr_b16 v[204:205], v249 offset:49152
  ds_read_b64_tr_b16 v[206:207], v249 offset:49664
  v_mfma_f32_32x32x16_bf16 v[160:175], v[216:219], v[96:99], v[160:175]
  ds_read_b64_tr_b16 v[208:209], v249 offset:51200
  ds_read_b64_tr_b16 v[210:211], v249 offset:51712
  v_mfma_f32_32x32x16_bf16 v[160:175], v[192:195], v[100:103], v[160:175]
  s_waitcnt lgkmcnt(4)
  ds_read_b64_tr_b16 v[212:213], v249 offset:53248
  ds_read_b64_tr_b16 v[214:215], v249 offset:53760
  v_mfma_f32_32x32x16_bf16 v[160:175], v[196:199], v[104:107], v[160:175]
  ds_read_b64_tr_b16 v[216:217], v249 offset:55296
  ds_read_b64_tr_b16 v[218:219], v249 offset:55808
  v_mfma_f32_32x32x16_bf16 v[160:175], v[200:203], v[108:111], v[160:175]
  s_waitcnt lgkmcnt(4)
  ds_read_b64_tr_b16 v[192:193], v250 offset:0
  ds_read_b64_tr_b16 v[194:195], v250 offset:512
  v_mfma_f32_32x32x16_bf16 v[160:175], v[204:207], v[112:115], v[160:175]
  ds_read_b64_tr_b16 v[196:197], v250 offset:2048
  ds_read_b64_tr_b16 v[198:199], v250 offset:2560
  v_mfma_f32_32x32x16_bf16 v[160:175], v[208:211], v[116:119], v[160:175]
  s_waitcnt lgkmcnt(4)
  ds_read_b64_tr_b16 v[200:201], v250 offset:4096
  ds_read_b64_tr_b16 v[202:203], v250 offset:4608
  v_mfma_f32_32x32x16_bf16 v[160:175], v[212:215], v[120:123], v[160:175]
  ds_read_b64_tr_b16 v[204:205], v250 offset:6144
  ds_read_b64_tr_b16 v[206:207], v250 offset:6656
  v_mfma_f32_32x32x16_bf16 v[160:175], v[216:219], v[124:127], v[160:175]
  s_waitcnt lgkmcnt(4)
  ds_read_b64_tr_b16 v[208:209], v250 offset:8192
  ds_read_b64_tr_b16 v[210:211], v250 offset:8704
  v_mfma_f32_32x32x16_bf16 v[176:191], v[192:195], v[16:19], v[176:191]
  ds_read_b64_tr_b16 v[212:213], v250 offset:10240
  ds_read_b64_tr_b16 v[214:215], v250 offset:10752
  v_mfma_f32_32x32x16_bf16 v[176:191], v[196:199], v[20:23], v[176:191]
  s_waitcnt lgkmcnt(4)
  ds_read_b64_tr_b16 v[216:217], v250 offset:12288
  ds_read_b64_tr_b16 v[218:219], v250 offset:12800
  v_mfma_f32_32x32x16_bf16 v[176:191], v[200:203], v[24:27], v[176:191]
  ds_read_b64_tr_b16 v[192:193], v250 offset:14336
  ds_read_b64_tr_b16 v[194:195], v250 offset:14848
  v_mul_f32 v220, 0x3fb8aa3b, v160
  v_mul_f32 v221, 0x3fb8aa3b, v161
  v_mul_f32 v222, 0x3fb8aa3b, v162
  v_mul_f32 v223, 0x3fb8aa3b, v163
  v_exp_f32 v220, v220
  v_mfma_f32_32x32x16_bf16 v[176:191], v[204:207], v[28:31], v[176:191]
  s_waitcnt lgkmcnt(4)
  ds_read_b64_tr_b16 v[196:197], v250 offset:16384
  ds_read_b64_tr_b16 v[198:199], v250 offset:16896
  v_exp_f32 v221, v221
  v_exp_f32 v222, v222
  v_exp_f32 v223, v223
  v_fma_f32 v224, v220, 0.5, 1.0
  v_mfma_f32_32x32x16_bf16 v[176:191], v[208:211], v[32:35], v[176:191]
  ds_read_b64_tr_b16 v[200:201], v250 offset:18432
  ds_read_b64_tr_b16 v[202:203], v250 offset:18944
  v_fma_f32 v225, v221, 0.5, 1.0
  v_fma_f32 v226, v222, 0.5, 1.0
  v_fma_f32 v227, v223, 0.5, 1.0
  v_fma_f32 v220, v220, v224, 1.0
  v_mfma_f32_32x32x16_bf16 v[176:191], v[212:215], v[36:39], v[176:191]
  s_waitcnt lgkmcnt(4)
  ds_read_b64_tr_b16 v[204:205], v250 offset:20480
  ds_read_b64_tr_b16 v[206:207], v250 offset:20992
  v_fma_f32 v221, v221, v225, 1.0
  v_fma_f32 v222, v222, v226, 1.0
  v_fma_f32 v223, v223, v227, 1.0
  v_rcp_f32 v220, v220
  v_rcp_f32 v221, v221
  v_mfma_f32_32x32x16_bf16 v[176:191], v[216:219], v[40:43], v[176:191]
  ds_read_b64_tr_b16 v[208:209], v250 offset:22528
  ds_read_b64_tr_b16 v[210:211], v250 offset:23040
  v_rcp_f32 v222, v222
  v_rcp_f32 v223, v223
  v_fma_f32 v160, -v160, v220, v160
  v_fma_f32 v161, -v161, v221, v161
  v_mfma_f32_32x32x16_bf16 v[176:191], v[192:195], v[44:47], v[176:191]
  s_waitcnt lgkmcnt(4)
  ds_read_b64_tr_b16 v[212:213], v250 offset:24576
  ds_read_b64_tr_b16 v[214:215], v250 offset:25088
  v_fma_f32 v162, -v162, v222, v162
  v_fma_f32 v163, -v163, v223, v163
  v_cvt_pk_bf16_f32 v160, v160, v161
  v_cvt_pk_bf16_f32 v161, v162, v163
  v_mfma_f32_32x32x16_bf16 v[176:191], v[196:199], v[48:51], v[176:191]
  ds_read_b64_tr_b16 v[216:217], v250 offset:26624
  ds_read_b64_tr_b16 v[218:219], v250 offset:27136
  v_mul_f32 v220, 0x3fb8aa3b, v164
  v_mul_f32 v221, 0x3fb8aa3b, v165
  v_mul_f32 v222, 0x3fb8aa3b, v166
  v_mul_f32 v223, 0x3fb8aa3b, v167
  v_exp_f32 v220, v220
  v_mfma_f32_32x32x16_bf16 v[176:191], v[200:203], v[52:55], v[176:191]
  s_waitcnt lgkmcnt(4)
  ds_read_b64_tr_b16 v[192:193], v250 offset:28672
  ds_read_b64_tr_b16 v[194:195], v250 offset:29184
  v_exp_f32 v221, v221
  v_exp_f32 v222, v222
  v_exp_f32 v223, v223
  v_fma_f32 v224, v220, 0.5, 1.0
  v_mfma_f32_32x32x16_bf16 v[176:191], v[204:207], v[56:59], v[176:191]
  ds_read_b64_tr_b16 v[196:197], v250 offset:30720
  ds_read_b64_tr_b16 v[198:199], v250 offset:31232
  v_fma_f32 v225, v221, 0.5, 1.0
  v_fma_f32 v226, v222, 0.5, 1.0
  v_fma_f32 v227, v223, 0.5, 1.0
  v_fma_f32 v220, v220, v224, 1.0
  v_mfma_f32_32x32x16_bf16 v[176:191], v[208:211], v[60:63], v[176:191]
  s_waitcnt lgkmcnt(4)
  ds_read_b64_tr_b16 v[200:201], v250 offset:32768
  ds_read_b64_tr_b16 v[202:203], v250 offset:33280
  v_fma_f32 v221, v221, v225, 1.0
  v_fma_f32 v222, v222, v226, 1.0
  v_fma_f32 v223, v223, v227, 1.0
  v_rcp_f32 v220, v220
  v_rcp_f32 v221, v221
  v_mfma_f32_32x32x16_bf16 v[176:191], v[212:215], v[64:67], v[176:191]
  ds_read_b64_tr_b16 v[204:205], v250 offset:34816
  ds_read_b64_tr_b16 v[206:207], v250 offset:35328
  v_rcp_f32 v222, v222
  v_rcp_f32 v223, v223
  v_fma_f32 v164, -v164, v220, v164
  v_fma_f32 v165, -v165, v221, v165
  v_mfma_f32_32x32x16_bf16 v[176:191], v[216:219], v[68:71], v[176:191]
  s_waitcnt lgkmcnt(4)
  ds_read_b64_tr_b16 v[208:209], v250 offset:36864
  ds_read_b64_tr_b16 v[210:211], v250 offset:37376
  v_fma_f32 v166, -v166, v222, v166
  v_fma_f32 v167, -v167, v223, v167
  v_cvt_pk_bf16_f32 v162, v164, v165
  v_cvt_pk_bf16_f32 v163, v166, v167
  v_mfma_f32_32x32x16_bf16 v[176:191], v[192:195], v[72:75], v[176:191]
  ds_read_b64_tr_b16 v[212:213], v250 offset:38912
  ds_read_b64_tr_b16 v[214:215], v250 offset:39424
  v_mul_f32 v220, 0x3fb8aa3b, v168
  v_mul_f32 v221, 0x3fb8aa3b, v169
  v_mul_f32 v222, 0x3fb8aa3b, v170
  v_mul_f32 v223, 0x3fb8aa3b, v171
  v_exp_f32 v220, v220
  v_mfma_f32_32x32x16_bf16 v[176:191], v[196:199], v[76:79], v[176:191]
  s_waitcnt lgkmcnt(4)
  ds_read_b64_tr_b16 v[216:217], v250 offset:40960
  ds_read_b64_tr_b16 v[218:219], v250 offset:41472
  v_exp_f32 v221, v221
  v_exp_f32 v222, v222
  v_exp_f32 v223, v223
  v_fma_f32 v224, v220, 0.5, 1.0
  v_mfma_f32_32x32x16_bf16 v[176:191], v[200:203], v[80:83], v[176:191]
  ds_read_b64_tr_b16 v[192:193], v250 offset:43008
  ds_read_b64_tr_b16 v[194:195], v250 offset:43520
  v_fma_f32 v225, v221, 0.5, 1.0
  v_fma_f32 v226, v222, 0.5, 1.0
  v_fma_f32 v227, v223, 0.5, 1.0
  v_fma_f32 v220, v220, v224, 1.0
  v_mfma_f32_32x32x16_bf16 v[176:191], v[204:207], v[84:87], v[176:191]
  s_waitcnt lgkmcnt(4)
  ds_read_b64_tr_b16 v[196:197], v250 offset:45056
  ds_read_b64_tr_b16 v[198:199], v250 offset:45568
  v_fma_f32 v221, v221, v225, 1.0
  v_fma_f32 v222, v222, v226, 1.0
  v_fma_f32 v223, v223, v227, 1.0
  v_rcp_f32 v220, v220
  v_rcp_f32 v221, v221
  v_mfma_f32_32x32x16_bf16 v[176:191], v[208:211], v[88:91], v[176:191]
  ds_read_b64_tr_b16 v[200:201], v250 offset:47104
  ds_read_b64_tr_b16 v[202:203], v250 offset:47616
  v_rcp_f32 v222, v222
  v_rcp_f32 v223, v223
  v_fma_f32 v168, -v168, v220, v168
  v_fma_f32 v169, -v169, v221, v169
  v_mfma_f32_32x32x16_bf16 v[176:191], v[212:215], v[92:95], v[176:191]
  s_waitcnt lgkmcnt(4)
  ds_read_b64_tr_b16 v[204:205], v250 offset:49152
  ds_read_b64_tr_b16 v[206:207], v250 offset:49664
  v_fma_f32 v170, -v170, v222, v170
  v_fma_f32 v171, -v171, v223, v171
  v_cvt_pk_bf16_f32 v164, v168, v169
  v_cvt_pk_bf16_f32 v165, v170, v171
  v_mfma_f32_32x32x16_bf16 v[176:191], v[216:219], v[96:99], v[176:191]
  ds_read_b64_tr_b16 v[208:209], v250 offset:51200
  ds_read_b64_tr_b16 v[210:211], v250 offset:51712
  v_mul_f32 v220, 0x3fb8aa3b, v172
  v_mul_f32 v221, 0x3fb8aa3b, v173
  v_mul_f32 v222, 0x3fb8aa3b, v174
  v_mul_f32 v223, 0x3fb8aa3b, v175
  v_exp_f32 v220, v220
  v_mfma_f32_32x32x16_bf16 v[176:191], v[192:195], v[100:103], v[176:191]
  s_waitcnt lgkmcnt(4)
  ds_read_b64_tr_b16 v[212:213], v250 offset:53248
  ds_read_b64_tr_b16 v[214:215], v250 offset:53760
  v_exp_f32 v221, v221
  v_exp_f32 v222, v222
  v_exp_f32 v223, v223
  v_fma_f32 v224, v220, 0.5, 1.0
  v_mfma_f32_32x32x16_bf16 v[176:191], v[196:199], v[104:107], v[176:191]
  ds_read_b64_tr_b16 v[216:217], v250 offset:55296
  ds_read_b64_tr_b16 v[218:219], v250 offset:55808
  v_fma_f32 v225, v221, 0.5, 1.0
  v_fma_f32 v226, v222, 0.5, 1.0
  v_fma_f32 v227, v223, 0.5, 1.0
  v_fma_f32 v220, v220, v224, 1.0
  v_mfma_f32_32x32x16_bf16 v[176:191], v[200:203], v[108:111], v[176:191]
  s_waitcnt lgkmcnt(4)
  v_fma_f32 v221, v221, v225, 1.0
  v_fma_f32 v222, v222, v226, 1.0
  v_fma_f32 v223, v223, v227, 1.0
  v_rcp_f32 v220, v220
  v_rcp_f32 v221, v221
  v_mfma_f32_32x32x16_bf16 v[176:191], v[204:207], v[112:115], v[176:191]
  v_rcp_f32 v222, v222
  v_rcp_f32 v223, v223
  v_fma_f32 v172, -v172, v220, v172
  v_fma_f32 v173, -v173, v221, v173
  v_mfma_f32_32x32x16_bf16 v[176:191], v[208:211], v[116:119], v[176:191]
  s_waitcnt lgkmcnt(0)
  v_fma_f32 v174, -v174, v222, v174
  v_fma_f32 v175, -v175, v223, v175
  v_cvt_pk_bf16_f32 v166, v172, v173
  v_cvt_pk_bf16_f32 v167, v174, v175
  v_mfma_f32_32x32x16_bf16 v[176:191], v[212:215], v[120:123], v[176:191]
  v_mfma_f32_32x32x16_bf16 v[176:191], v[216:219], v[124:127], v[176:191]
  v_mov_b32 v3, 155648
  v_mov_b32 v4, 1
  s_mov_b64 exec, 1
  ds_add_u32 v3, v4 offset:0
  s_mov_b64 exec, -1
  s_nop 6
  v_mul_f32 v220, 0x3fb8aa3b, v176
  v_mul_f32 v221, 0x3fb8aa3b, v177
  v_mul_f32 v222, 0x3fb8aa3b, v178
  v_mul_f32 v223, 0x3fb8aa3b, v179
  v_exp_f32 v220, v220
  v_exp_f32 v221, v221
  v_exp_f32 v222, v222
  v_exp_f32 v223, v223
  v_fma_f32 v224, v220, 0.5, 1.0
  v_fma_f32 v225, v221, 0.5, 1.0
  v_fma_f32 v226, v222, 0.5, 1.0
  v_fma_f32 v227, v223, 0.5, 1.0
  v_fma_f32 v220, v220, v224, 1.0
  v_fma_f32 v221, v221, v225, 1.0
  v_fma_f32 v222, v222, v226, 1.0
  v_fma_f32 v223, v223, v227, 1.0
  v_rcp_f32 v220, v220
  v_rcp_f32 v221, v221
  v_rcp_f32 v222, v222
  v_rcp_f32 v223, v223
  v_fma_f32 v176, -v176, v220, v176
  v_fma_f32 v177, -v177, v221, v177
  v_fma_f32 v178, -v178, v222, v178
  v_fma_f32 v179, -v179, v223, v179
  v_cvt_pk_bf16_f32 v176, v176, v177
  v_cvt_pk_bf16_f32 v177, v178, v179
  v_mul_f32 v220, 0x3fb8aa3b, v180
  v_mul_f32 v221, 0x3fb8aa3b, v181
  v_mul_f32 v222, 0x3fb8aa3b, v182
  v_mul_f32 v223, 0x3fb8aa3b, v183
  v_exp_f32 v220, v220
  v_exp_f32 v221, v221
  v_exp_f32 v222, v222
  v_exp_f32 v223, v223
  v_fma_f32 v224, v220, 0.5, 1.0
  v_fma_f32 v225, v221, 0.5, 1.0
  v_fma_f32 v226, v222, 0.5, 1.0
  v_fma_f32 v227, v223, 0.5, 1.0
  v_fma_f32 v220, v220, v224, 1.0
  v_fma_f32 v221, v221, v225, 1.0
  v_fma_f32 v222, v222, v226, 1.0
  v_fma_f32 v223, v223, v227, 1.0
  v_rcp_f32 v220, v220
  v_rcp_f32 v221, v221
  v_rcp_f32 v222, v222
  v_rcp_f32 v223, v223
  v_fma_f32 v180, -v180, v220, v180
  v_fma_f32 v181, -v181, v221, v181
  v_fma_f32 v182, -v182, v222, v182
  v_fma_f32 v183, -v183, v223, v183
  v_cvt_pk_bf16_f32 v178, v180, v181
  v_cvt_pk_bf16_f32 v179, v182, v183
  v_mul_f32 v220, 0x3fb8aa3b, v184
  v_mul_f32 v221, 0x3fb8aa3b, v185
  v_mul_f32 v222, 0x3fb8aa3b, v186
  v_mul_f32 v223, 0x3fb8aa3b, v187
  v_exp_f32 v220, v220
  v_exp_f32 v221, v221
  v_exp_f32 v222, v222
  v_exp_f32 v223, v223
  v_fma_f32 v224, v220, 0.5, 1.0
  v_fma_f32 v225, v221, 0.5, 1.0
  v_fma_f32 v226, v222, 0.5, 1.0
  v_fma_f32 v227, v223, 0.5, 1.0
  v_fma_f32 v220, v220, v224, 1.0
  v_fma_f32 v221, v221, v225, 1.0
  v_fma_f32 v222, v222, v226, 1.0
  v_fma_f32 v223, v223, v227, 1.0
  v_rcp_f32 v220, v220
  v_rcp_f32 v221, v221
  v_rcp_f32 v222, v222
  v_rcp_f32 v223, v223
  v_fma_f32 v184, -v184, v220, v184
  v_fma_f32 v185, -v185, v221, v185
  v_fma_f32 v186, -v186, v222, v186
  v_fma_f32 v187, -v187, v223, v187
  v_cvt_pk_bf16_f32 v180, v184, v185
  v_cvt_pk_bf16_f32 v181, v186, v187
  v_mul_f32 v220, 0x3fb8aa3b, v188
  v_mul_f32 v221, 0x3fb8aa3b, v189
  v_mul_f32 v222, 0x3fb8aa3b, v190
  v_mul_f32 v223, 0x3fb8aa3b, v191
  v_exp_f32 v220, v220
  v_exp_f32 v221, v221
  v_exp_f32 v222, v222
  v_exp_f32 v223, v223
  v_fma_f32 v224, v220, 0.5, 1.0
  v_fma_f32 v225, v221, 0.5, 1.0
  v_fma_f32 v226, v222, 0.5, 1.0
  v_fma_f32 v227, v223, 0.5, 1.0
  v_fma_f32 v220, v220, v224, 1.0
  v_fma_f32 v221, v221, v225, 1.0
  v_fma_f32 v222, v222, v226, 1.0
  v_fma_f32 v223, v223, v227, 1.0
  v_rcp_f32 v220, v220
  v_rcp_f32 v221, v221
  v_rcp_f32 v222, v222
  v_rcp_f32 v223, v223
  v_fma_f32 v188, -v188, v220, v188
  v_fma_f32 v189, -v189, v221, v189
  v_fma_f32 v190, -v190, v222, v190
  v_fma_f32 v191, -v191, v223, v191
  v_cvt_pk_bf16_f32 v182, v188, v189
  v_cvt_pk_bf16_f32 v183, v190, v191
  v_mov_b32 v3, 155648
  s_mov_b32 s66, 1048576
LP_f5173:
  ds_read_b32 v4, v3 offset:0
  s_sub_u32 s66, s66, 1
  s_waitcnt lgkmcnt(0)
  v_readfirstlane_b32 s3, v4
  s_nop 0
  s_cmp_lt_u32 s3, 1036
  s_cselect_b32 s3, s66, 0
  s_cmp_lg_u32 s3, 0
  s_cbranch_scc1 LP_f5173
  v_mov_b32 v3, 155648
  s_mov_b32 s66, 1048576
LP_f5174:
  ds_read_b32 v4, v3 offset:4
  s_sub_u32 s66, s66, 1
  s_waitcnt lgkmcnt(0)
  v_readfirstlane_b32 s3, v4
  s_nop 0
  s_cmp_lt_u32 s3, 262144
  s_cselect_b32 s3, s66, 0
  s_cmp_lg_u32 s3, 0
  s_cbranch_scc1 LP_f5174
  s_setprio 0
  s_cmp_eq_u32 s57, 1
  s_cbranch_scc0 EL_f5175
  s_waitcnt vmcnt(3)
  buffer_store_dwordx4 v[128:131], v2, s[36:39], s4 offen offset:0 sc1
  s_waitcnt vmcnt(3)
  buffer_store_dwordx4 v[132:135], v2, s[36:39], s4 offen offset:1024 sc1
  s_add_u32 s4, s4, 2048
  s_waitcnt vmcnt(3)
  buffer_store_dwordx4 v[144:147], v2, s[36:39], s4 offen offset:0 sc1
  s_waitcnt vmcnt(3)
  buffer_store_dwordx4 v[148:151], v2, s[36:39], s4 offen offset:1024 sc1
  s_add_u32 s4, s4, 2048
  s_branch EN_f5176
EL_f5175:
  s_cmp_eq_u32 s54, 3
  s_cbranch_scc0 EL_f5177
  s_lshl_b32 s3, s55, 7
  s_add_u32 s59, s3, 393216
  buffer_store_dword v128, v129, s[36:39], s59 offen sc1
EL_f5177:
EN_f5176:
  s_waitcnt vmcnt(3)
  buffer_store_dwordx4 v[160:163], v2, s[36:39], s4 offen offset:0 sc1
  s_waitcnt vmcnt(3)
  buffer_store_dwordx4 v[164:167], v2, s[36:39], s4 offen offset:1024 sc1
  s_add_u32 s4, s4, 2048
  s_waitcnt vmcnt(3)
  buffer_store_dwordx4 v[176:179], v2, s[36:39], s4 offen offset:0 sc1
  s_waitcnt vmcnt(3)
  buffer_store_dwordx4 v[180:183], v2, s[36:39], s4 offen offset:1024 sc1
  s_add_u32 s4, s4, 2048
  s_add_u32 s10, s10, 65536
  s_setprio 2
  s_cmp_ge_u32 s2, 224
  s_cbranch_scc0 EL_f5179
  s_waitcnt vmcnt(0)
  s_setprio 2
  v_mov_b32 v3, 155648
  v_mov_b32 v4, 1
  s_mov_b64 exec, 1
  ds_add_rtn_u32 v4, v3, v4 offset:12
  s_mov_b64 exec, -1
  s_waitcnt lgkmcnt(0)
  v_readfirstlane_b32 s3, v4
  s_nop 0
  s_cmp_eq_u32 s3, 3
  s_cbranch_scc0 EL_f5181
  s_mov_b64 exec, 0xff
  buffer_store_dwordx4 v[12:15], v2, s[36:39], s10 offen sc1
  s_mov_b64 exec, -1
EL_f5181:
  v_mov_b32 v3, 155648
  v_mov_b32 v4, 1
  s_mov_b64 exec, 1
  ds_add_u32 v3, v4 offset:20
  s_mov_b64 exec, -1
  s_barrier
  s_lshl_b32 s3, s2, 2
  s_add_u32 s3, s3, s67
  s_cmp_eq_u32 s3, 1023
  s_cbranch_scc0 EL_f5183
  v_lshlrev_b32 v3, 9, v1
  v_add_u32 v3, 32768, v3
  s_mov_b32 s66, 65536
  s_mov_b64 exec, -1
LP_f5185:
  buffer_load_dword v192, v3, s[36:39], 0 offen offset:0 sc1
  buffer_load_dword v193, v3, s[36:39], 0 offen offset:128 sc1
  buffer_load_dword v194, v3, s[36:39], 0 offen offset:256 sc1
  buffer_load_dword v195, v3, s[36:39], 0 offen offset:384 sc1
  s_sub_u32 s66, s66, 1
  s_waitcnt vmcnt(3)
  v_cmp_ne_u32 vcc, s65, v192
  s_waitcnt vmcnt(2)
  v_cmp_ne_u32 s[68:69], s65, v193
  s_nop 0
  s_or_b64 vcc, vcc, s[68:69]
  s_waitcnt vmcnt(1)
  v_cmp_ne_u32 s[68:69], s65, v194
  s_nop 0
  s_or_b64 vcc, vcc, s[68:69]
  s_waitcnt vmcnt(0)
  v_cmp_ne_u32 s[68:69], s65, v195
  s_nop 0
  s_or_b64 vcc, vcc, s[68:69]
  s_cmp_lg_u64 vcc, 0
  s_cselect_b32 s3, s66, 0
  s_cmp_lg_u32 s3, 0
  s_cbranch_scc1 LP_f5185
  s_mov_b64 exec, -1
  s_mov_b64 exec, 0xff
  buffer_store_dwordx4 v[12:15], v2, s[36:39], 0 offen sc1
  s_mov_b64 exec, -1
EL_f5183:
  s_endpgm
EL_f5179:
  s_lshl_b32 s59, s5, 2
  s_add_u32 s59, s59, s67
  s_mul_i32 s59, s59, 7
  s_mul_i32 s3, s6, 224
  s_add_u32 s3, s3, s59
  s_add_u32 s3, s3, s7
  s_lshl_b32 s3, s3, 11
  s_add_u32 s3, s3, 7340032
  v_lshrrev_b32 v3, 4, v1
  v_mul_u32_u24 v3, 112640, v3
  v_lshl_add_u32 v3, v1, 7, v3
  v_add_u32 v250, s3, v3
  s_lshl_b32 s3, s5, 7
  s_add_u32 s3, s3, s6
  s_lshl_b32 s3, s3, 7
  s_add_u32 s3, s3, 65536
  v_lshl_add_u32 v5, v1, 11, s3
  s_lshl_b32 s3, s6, 7
  s_add_u32 s3, s3, 71680
  v_writelane_b32 v5, s3, 8
  s_lshl_b32 s60, s6, 1
  s_add_u32 s60, s60, s5
  s_lshl_b32 s60, s60, 1
  s_and_b32 s3, s67, 1
  s_add_u32 s60, s60, s3
  s_xor_b32 s3, s60, 2
  s_mul_i32 s13, s3, 7
  s_add_u32 s13, s13, s7
  s_lshl_b32 s13, s13, 1
  s_lshr_b32 s3, s67, 1
  s_add_u32 s13, s13, s3
  s_lshl_b32 s13, s13, 12
  s_add_u32 s13, s13, 16777216
  s_mov_b32 s14, 0x07060500
  s_mov_b32 s18, 0x07060501
  s_xor_b32 s3, s60, 3
  s_mul_i32 s3, s3, 56
  s_add_u32 s3, s3, s59
  s_lshl_b32 s3, s3, 11
  s_add_u32 s8, s3, 7340032
  s_xor_b32 s3, s60, 1
  s_mul_i32 s3, s3, 56
  s_add_u32 s3, s3, s59
  s_lshl_b32 s3, s3, 11
  s_add_u32 s9, s3, 7340032
  s_xor_b32 s3, s60, 2
  s_mul_i32 s3, s3, 56
  s_add_u32 s3, s3, s59
  s_lshl_b32 s3, s3, 11
  s_add_u32 s11, s3, 7340032
  s_xor_b32 s3, s60, 0
  s_mul_i32 s3, s3, 56
  s_add_u32 s3, s3, s59
  s_lshl_b32 s3, s3, 11
  s_add_u32 s12, s3, 7340032
  s_xor_b32 s3, s67, 0
  s_mul_i32 s3, s3, 12288
  s_add_u32 s3, s3, 57344
  v_add_u32 v11, s3, v2
  s_xor_b32 s3, s67, 1
  s_mul_i32 s3, s3, 12288
  s_add_u32 s3, s3, 57344
  v_add_u32 v9, s3, v2
  s_xor_b32 s3, s67, 2
  s_mul_i32 s3, s3, 12288
  s_add_u32 s3, s3, 57344
  v_add_u32 v0, s3, v2
  v_add_u32 v251, 65536, v7
  v_add_u32 v252, 65536, v8
  v_add_u32 v253, 131072, v7
  v_add_u32 v254, 131072, v8
  s_setprio 0
  s_add_u32 m0, s61, 0
  s_mov_b32 s64, 0
  s_waitcnt vmcnt(3)
  buffer_load_dwordx4 v6, s[44:47], s64 offen lds
  s_mov_b32 s64, 6144
  s_waitcnt vmcnt(3)
  buffer_load_dwordx4 v6, s[44:47], s64 offen offset:1024 lds
  s_add_u32 m0, s61, 8192
  s_mov_b32 s64, 14336
  s_waitcnt vmcnt(3)
  buffer_load_dwordx4 v6, s[44:47], s64 offen lds
  s_mov_b32 s64, 20480
  s_waitcnt vmcnt(3)
  buffer_load_dwordx4 v6, s[44:47], s64 offen offset:1024 lds
  s_add_u32 m0, s61, 57344
  s_mov_b32 s64, 28672
  s_waitcnt vmcnt(3)
  buffer_load_dwordx4 v6, s[44:47], s64 offen lds
  s_mov_b32 s64, 34816
  s_waitcnt vmcnt(3)
  buffer_load_dwordx4 v6, s[44:47], s64 offen offset:1024 lds
  s_setprio 2
  v_mov_b32 v3, 155648
  v_mov_b32 v4, 1
  s_mov_b64 exec, 1
  ds_add_rtn_u32 v4, v3, v4 offset:12
  s_mov_b64 exec, -1
  s_waitcnt lgkmcnt(0)
  v_readfirstlane_b32 s3, v4
  s_nop 0
  s_cmp_eq_u32 s3, 3
  s_cbranch_scc0 EL_f5186
  s_mov_b64 exec, 0xff
  buffer_store_dwordx4 v[12:15], v2, s[36:39], s10 offen sc1
  s_mov_b64 exec, -1
EL_f5186:
  s_setprio 0
  s_add_u32 m0, s61, 65536
  s_mov_b32 s64, 43008
  s_waitcnt vmcnt(3)
  buffer_load_dwordx4 v6, s[44:47], s64 offen lds
  s_mov_b32 s64, 49152
  s_waitcnt vmcnt(3)
  buffer_load_dwordx4 v6, s[44:47], s64 offen offset:1024 lds
  ds_read_b64_tr_b16 v[16:17], v7 offset:0
  ds_read_b64_tr_b16 v[18:19], v7 offset:1024
  ds_read_b64_tr_b16 v[20:21], v8 offset:0
  ds_read_b64_tr_b16 v[22:23], v8 offset:1024
  s_add_u32 m0, s61, 73728
  s_mov_b32 s64, 57344
  s_waitcnt vmcnt(3)
  buffer_load_dwordx4 v6, s[44:47], s64 offen lds
  s_mov_b32 s64, 63488
  s_waitcnt vmcnt(3)
  buffer_load_dwordx4 v6, s[44:47], s64 offen offset:1024 lds
  ds_read_b64_tr_b16 v[24:25], v7 offset:8192
  ds_read_b64_tr_b16 v[26:27], v7 offset:9216
  ds_read_b64_tr_b16 v[28:29], v8 offset:8192
  ds_read_b64_tr_b16 v[30:31], v8 offset:9216
  s_add_u32 m0, s61, 81920
  s_mov_b32 s64, 71680
  s_waitcnt vmcnt(3)
  buffer_load_dwordx4 v6, s[44:47], s64 offen lds
  s_mov_b32 s64, 77824
  s_waitcnt vmcnt(3)
  buffer_load_dwordx4 v6, s[44:47], s64 offen offset:1024 lds
  ds_read_b64_tr_b16 v[32:33], v7 offset:57344
  ds_read_b64_tr_b16 v[34:35], v7 offset:58368
  ds_read_b64_tr_b16 v[36:37], v8 offset:57344
  ds_read_b64_tr_b16 v[38:39], v8 offset:58368
  s_add_u32 m0, s61, 90112
  s_mov_b32 s64, 86016
  s_waitcnt vmcnt(3)
  buffer_load_dwordx4 v6, s[44:47], s64 offen lds
  s_mov_b32 s64, 92160
  s_waitcnt vmcnt(3)
  buffer_load_dwordx4 v6, s[44:47], s64 offen offset:1024 lds
  ds_read_b64_tr_b16 v[40:41], v251 offset:0
  ds_read_b64_tr_b16 v[42:43], v251 offset:1024
  ds_read_b64_tr_b16 v[44:45], v252 offset:0
  ds_read_b64_tr_b16 v[46:47], v252 offset:1024
  s_add_u32 m0, s61, 98304
  s_mov_b32 s64, 100352
  s_waitcnt vmcnt(3)
  buffer_load_dwordx4 v6, s[44:47], s64 offen lds
  s_mov_b32 s64, 106496
  s_waitcnt vmcnt(3)
  buffer_load_dwordx4 v6, s[44:47], s64 offen offset:1024 lds
  ds_read_b64_tr_b16 v[48:49], v251 offset:8192
  ds_read_b64_tr_b16 v[50:51], v251 offset:9216
  ds_read_b64_tr_b16 v[52:53], v252 offset:8192
  ds_read_b64_tr_b16 v[54:55], v252 offset:9216
  s_add_u32 m0, s61, 106496
  s_mov_b32 s64, 114688
  s_waitcnt vmcnt(3)
  buffer_load_dwordx4 v6, s[44:47], s64 offen lds
  s_mov_b32 s64, 120832
  s_waitcnt vmcnt(3)
  buffer_load_dwordx4 v6, s[44:47], s64 offen offset:1024 lds
  ds_read_b64_tr_b16 v[56:57], v251 offset:16384
  ds_read_b64_tr_b16 v[58:59], v251 offset:17408
  ds_read_b64_tr_b16 v[60:61], v252 offset:16384
  ds_read_b64_tr_b16 v[62:63], v252 offset:17408
  s_add_u32 m0, s61, 114688
  s_mov_b32 s64, 129024
  s_waitcnt vmcnt(3)
  buffer_load_dwordx4 v6, s[44:47], s64 offen lds
  s_mov_b32 s64, 135168
  s_waitcnt vmcnt(3)
  buffer_load_dwordx4 v6, s[44:47], s64 offen offset:1024 lds
  ds_read_b64_tr_b16 v[64:65], v251 offset:24576
  ds_read_b64_tr_b16 v[66:67], v251 offset:25600
  ds_read_b64_tr_b16 v[68:69], v252 offset:24576
  ds_read_b64_tr_b16 v[70:71], v252 offset:25600
  s_add_u32 m0, s61, 122880
  s_mov_b32 s64, 143360
  s_waitcnt vmcnt(3)
  buffer_load_dwordx4 v6, s[44:47], s64 offen lds
  s_mov_b32 s64, 149504
  s_waitcnt vmcnt(3)
  buffer_load_dwordx4 v6, s[44:47], s64 offen offset:1024 lds
  ds_read_b64_tr_b16 v[72:73], v251 offset:32768
  ds_read_b64_tr_b16 v[74:75], v251 offset:33792
  ds_read_b64_tr_b16 v[76:77], v252 offset:32768
  ds_read_b64_tr_b16 v[78:79], v252 offset:33792
  s_add_u32 m0, s61, 131072
  s_mov_b32 s64, 157696
  s_waitcnt vmcnt(3)
  buffer_load_dwordx4 v6, s[44:47], s64 offen lds
  s_mov_b32 s64, 163840
  s_waitcnt vmcnt(3)
  buffer_load_dwordx4 v6, s[44:47], s64 offen offset:1024 lds
  ds_read_b64_tr_b16 v[80:81], v251 offset:40960
  ds_read_b64_tr_b16 v[82:83], v251 offset:41984
  ds_read_b64_tr_b16 v[84:85], v252 offset:40960
  ds_read_b64_tr_b16 v[86:87], v252 offset:41984
  s_add_u32 m0, s61, 139264
  s_mov_b32 s64, 172032
  s_waitcnt vmcnt(3)
  buffer_load_dwordx4 v6, s[44:47], s64 offen lds
  s_mov_b32 s64, 178176
  s_waitcnt vmcnt(3)
  buffer_load_dwordx4 v6, s[44:47], s64 offen offset:1024 lds
  ds_read_b64_tr_b16 v[88:89], v251 offset:49152
  ds_read_b64_tr_b16 v[90:91], v251 offset:50176
  ds_read_b64_tr_b16 v[92:93], v252 offset:49152
  ds_read_b64_tr_b16 v[94:95], v252 offset:50176
  s_add_u32 m0, s61, 147456
  s_mov_b32 s64, 186368
  s_waitcnt vmcnt(3)
  buffer_load_dwordx4 v6, s[44:47], s64 offen lds
  s_mov_b32 s64, 192512
  s_waitcnt vmcnt(3)
  buffer_load_dwordx4 v6, s[44:47], s64 offen offset:1024 lds
  ds_read_b64_tr_b16 v[96:97], v251 offset:57344
  ds_read_b64_tr_b16 v[98:99], v251 offset:58368
  ds_read_b64_tr_b16 v[100:101], v252 offset:57344
  ds_read_b64_tr_b16 v[102:103], v252 offset:58368
  s_add_u32 m0, s61, 16384
  s_mov_b32 s64, 114688
  s_waitcnt vmcnt(3)
  buffer_load_dwordx4 v6, s[48:51], s64 offen lds
  s_mov_b32 s64, 120832
  s_waitcnt vmcnt(3)
  buffer_load_dwordx4 v6, s[48:51], s64 offen offset:1024 lds
  ds_read_b64_tr_b16 v[104:105], v253 offset:0
  ds_read_b64_tr_b16 v[106:107], v253 offset:1024
  ds_read_b64_tr_b16 v[108:109], v254 offset:0
  ds_read_b64_tr_b16 v[110:111], v254 offset:1024
  s_add_u32 m0, s61, 24576
  s_mov_b32 s64, 172032
  s_waitcnt vmcnt(3)
  buffer_load_dwordx4 v6, s[48:51], s64 offen lds
  s_mov_b32 s64, 178176
  s_waitcnt vmcnt(3)
  buffer_load_dwordx4 v6, s[48:51], s64 offen offset:1024 lds
  ds_read_b64_tr_b16 v[112:113], v253 offset:8192
  ds_read_b64_tr_b16 v[114:115], v253 offset:9216
  ds_read_b64_tr_b16 v[116:117], v254 offset:8192
  ds_read_b64_tr_b16 v[118:119], v254 offset:9216
  s_add_u32 m0, s61, 32768
  s_mov_b32 s64, 229376
  s_waitcnt vmcnt(3)
  buffer_load_dwordx4 v6, s[48:51], s64 offen lds
  s_mov_b32 s64, 235520
  s_waitcnt vmcnt(3)
  buffer_load_dwordx4 v6, s[48:51], s64 offen offset:1024 lds
  ds_read_b64_tr_b16 v[120:121], v253 offset:16384
  ds_read_b64_tr_b16 v[122:123], v253 offset:17408
  ds_read_b64_tr_b16 v[124:125], v254 offset:16384
  ds_read_b64_tr_b16 v[126:127], v254 offset:17408
  s_add_u32 m0, s61, 40960
  s_mov_b32 s64, 286720
  s_waitcnt vmcnt(3)
  buffer_load_dwordx4 v6, s[48:51], s64 offen lds
  s_mov_b32 s64, 292864
  s_waitcnt vmcnt(3)
  buffer_load_dwordx4 v6, s[48:51], s64 offen offset:1024 lds
  s_add_u32 m0, s61, 49152
  s_mov_b32 s64, 344064
  s_waitcnt vmcnt(3)
  buffer_load_dwordx4 v6, s[48:51], s64 offen lds
  s_mov_b32 s64, 350208
  s_waitcnt vmcnt(3)
  buffer_load_dwordx4 v6, s[48:51], s64 offen offset:1024 lds
  s_waitcnt lgkmcnt(15)
  s_add_u32 m0, s61, 0
  s_mov_b32 s64, 0
  s_waitcnt vmcnt(3)
  buffer_load_dwordx4 v6, s[48:51], s64 offen lds
  s_mov_b32 s64, 6144
  s_waitcnt vmcnt(3)
  buffer_load_dwordx4 v6, s[48:51], s64 offen offset:1024 lds
  s_add_u32 m0, s61, 8192
  s_mov_b32 s64, 57344
  s_waitcnt vmcnt(3)
  buffer_load_dwordx4 v6, s[48:51], s64 offen lds
  s_mov_b32 s64, 63488
  s_waitcnt vmcnt(3)
  buffer_load_dwordx4 v6, s[48:51], s64 offen offset:1024 lds
  s_setprio 2
  v_mov_b32 v3, 155648
  v_mov_b32 v1, 1
  s_mov_b64 exec, 0x1ff
  buffer_load_dword v10, v5, s[36:39], 0 offen sc1
  s_waitcnt vmcnt(1) lgkmcnt(0)
  s_mov_b64 exec, 1
  ds_add_u32 v3, v1 offset:20
  s_mov_b64 exec, -1
  s_waitcnt vmcnt(0)
  v_cmp_ne_u32 vcc, s65, v10
  s_nop 0
  s_and_b32 s3, vcc_lo, 0x1ff
  s_cbranch_scc0 EL_f5188
  s_mov_b32 s66, 65536
  s_mov_b64 exec, 0x1ff
LP_f5190:
  buffer_load_dword v10, v5, s[36:39], 0 offen offset:0 sc1
  s_sub_u32 s66, s66, 1
  s_waitcnt vmcnt(0)
  v_cmp_ne_u32 vcc, s65, v10
  s_nop 0
  s_cmp_lg_u64 vcc, 0
  s_cselect_b32 s3, s66, 0
  s_cmp_lg_u32 s3, 0
  s_cbranch_scc1 LP_f5190
  s_mov_b64 exec, -1
EL_f5188:
  v_mov_b32 v5, 0x10000
  s_setprio 0
  s_add_u32 s67, s8, 0
  s_waitcnt vmcnt(3)
  buffer_load_dwordx4 v[128:131], v2, s[36:39], s67 offen offset:0 sc1
  s_waitcnt vmcnt(3)
  buffer_load_dwordx4 v[132:135], v2, s[36:39], s67 offen offset:1024 sc1
  s_waitcnt vmcnt(3)
  buffer_load_dwordx4 v[136:139], v2, s[36:39], s67 offen offset:2048 sc1
  s_waitcnt vmcnt(3)
  buffer_load_dwordx4 v[140:143], v2, s[36:39], s67 offen offset:3072 sc1
  s_add_u32 s67, s8, 4096
  s_waitcnt vmcnt(3)
  buffer_load_dwordx4 v[160:163], v2, s[36:39], s67 offen offset:0 sc1
  s_waitcnt vmcnt(3)
  buffer_load_dwordx4 v[164:167], v2, s[36:39], s67 offen offset:1024 sc1
  s_waitcnt vmcnt(3)
  buffer_load_dwordx4 v[168:171], v2, s[36:39], s67 offen offset:2048 sc1
  s_waitcnt vmcnt(3)
  buffer_load_dwordx4 v[172:175], v2, s[36:39], s67 offen offset:3072 sc1
  s_add_u32 s67, s8, 8192
  s_waitcnt vmcnt(3)
  buffer_load_dwordx4 v[192:195], v2, s[36:39], s67 offen offset:0 sc1
  s_waitcnt vmcnt(3)
  buffer_load_dwordx4 v[196:199], v2, s[36:39], s67 offen offset:1024 sc1
  s_waitcnt vmcnt(3)
  buffer_load_dwordx4 v[200:203], v2, s[36:39], s67 offen offset:2048 sc1
  s_waitcnt vmcnt(3)
  buffer_load_dwordx4 v[204:207], v2, s[36:39], s67 offen offset:3072 sc1
  s_add_u32 s67, s8, 12288
  s_waitcnt vmcnt(3)
  buffer_load_dwordx4 v[208:211], v2, s[36:39], s67 offen offset:0 sc1
  s_waitcnt vmcnt(3)
  buffer_load_dwordx4 v[212:215], v2, s[36:39], s67 offen offset:1024 sc1
  s_add_u32 s67, s9, 0
  s_waitcnt vmcnt(3)
  buffer_load_dwordx4 v[216:219], v2, s[36:39], s67 offen offset:0 sc1
  s_waitcnt vmcnt(3)
  buffer_load_dwordx4 v[220:223], v2, s[36:39], s67 offen offset:1024 sc1
  s_waitcnt vmcnt(3)
  buffer_load_dwordx4 v[224:227], v2, s[36:39], s67 offen offset:2048 sc1
  s_waitcnt vmcnt(3)
  buffer_load_dwordx4 v[228:231], v2, s[36:39], s67 offen offset:3072 sc1
  s_add_u32 s67, s9, 4096
  s_waitcnt vmcnt(3)
  buffer_load_dwordx4 v[232:235], v2, s[36:39], s67 offen offset:0 sc1
  s_waitcnt vmcnt(3)
  buffer_load_dwordx4 v[236:239], v2, s[36:39], s67 offen offset:1024 sc1
  s_waitcnt vmcnt(3)
  buffer_load_dwordx4 v[240:243], v2, s[36:39], s67 offen offset:2048 sc1
  s_waitcnt vmcnt(3)
  buffer_load_dwordx4 v[244:247], v2, s[36:39], s67 offen offset:3072 sc1
  s_add_u32 s67, s9, 8192
  s_waitcnt vmcnt(3)
  buffer_load_dwordx4 v[248:251], v2, s[36:39], s67 offen offset:0 sc1
  s_waitcnt vmcnt(3)
  buffer_load_dwordx4 v[252:255], v2, s[36:39], s67 offen offset:1024 sc1
  s_barrier
  s_setprio 2
  v_mfma_f32_32x32x16_bf16 v[144:159], v[16:19], v[128:131], 0
  v_mfma_f32_32x32x16_bf16 v[176:191], v[20:23], v[128:131], 0
  v_mfma_f32_32x32x16_bf16 v[144:159], v[24:27], v[132:135], v[144:159]
  v_mfma_f32_32x32x16_bf16 v[176:191], v[28:31], v[132:135], v[176:191]
  v_mfma_f32_32x32x16_bf16 v[144:159], v[32:35], v[136:139], v[144:159]
  v_mfma_f32_32x32x16_bf16 v[176:191], v[36:39], v[136:139], v[176:191]
  v_mfma_f32_32x32x16_bf16 v[144:159], v[40:43], v[140:143], v[144:159]
  v_mfma_f32_32x32x16_bf16 v[176:191], v[44:47], v[140:143], v[176:191]
  v_mfma_f32_32x32x16_bf16 v[144:159], v[48:51], v[160:163], v[144:159]
  v_mfma_f32_32x32x16_bf16 v[176:191], v[52:55], v[160:163], v[176:191]
  v_mfma_f32_32x32x16_bf16 v[144:159], v[56:59], v[164:167], v[144:159]
  v_mfma_f32_32x32x16_bf16 v[176:191], v[60:63], v[164:167], v[176:191]
  v_mfma_f32_32x32x16_bf16 v[144:159], v[64:67], v[168:171], v[144:159]
  v_mfma_f32_32x32x16_bf16 v[176:191], v[68:71], v[168:171], v[176:191]
  v_mfma_f32_32x32x16_bf16 v[144:159], v[72:75], v[172:175], v[144:159]
  v_mfma_f32_32x32x16_bf16 v[176:191], v[76:79], v[172:175], v[176:191]
  v_mfma_f32_32x32x16_bf16 v[144:159], v[80:83], v[192:195], v[144:159]
  v_mfma_f32_32x32x16_bf16 v[176:191], v[84:87], v[192:195], v[176:191]
  buffer_load_dwordx4 v[192:195], v2, s[36:39], s67 offen offset:2048 sc1
  v_mfma_f32_32x32x16_bf16 v[144:159], v[88:91], v[196:199], v[144:159]
  v_mfma_f32_32x32x16_bf16 v[176:191], v[92:95], v[196:199], v[176:191]
  buffer_load_dwordx4 v[196:199], v2, s[36:39], s67 offen offset:3072 sc1
  v_mfma_f32_32x32x16_bf16 v[144:159], v[96:99], v[200:203], v[144:159]
  v_mfma_f32_32x32x16_bf16 v[176:191], v[100:103], v[200:203], v[176:191]
  s_add_u32 s67, s9, 12288
  buffer_load_dwordx4 v[200:203], v2, s[36:39], s67 offen offset:0 sc1
  v_mfma_f32_32x32x16_bf16 v[144:159], v[104:107], v[204:207], v[144:159]
  v_mfma_f32_32x32x16_bf16 v[176:191], v[108:111], v[204:207], v[176:191]
  buffer_load_dwordx4 v[204:207], v2, s[36:39], s67 offen offset:1024 sc1
  v_mfma_f32_32x32x16_bf16 v[144:159], v[112:115], v[208:211], v[144:159]
  v_mfma_f32_32x32x16_bf16 v[176:191], v[116:119], v[208:211], v[176:191]
  s_add_u32 s67, s11, 0
  buffer_load_dwordx4 v[208:211], v2, s[36:39], s67 offen offset:0 sc1
  v_mfma_f32_32x32x16_bf16 v[144:159], v[120:123], v[212:215], v[144:159]
  v_mfma_f32_32x32x16_bf16 v[176:191], v[124:127], v[212:215], v[176:191]
  buffer_load_dwordx4 v[212:215], v2, s[36:39], s67 offen offset:1024 sc1
  v_mfma_f32_32x32x16_bf16 v[128:143], v[16:19], v[216:219], 0
  s_nop 8
  ds_write_b128 v9, v[144:147] offset:0
  v_mfma_f32_32x32x16_bf16 v[160:175], v[20:23], v[216:219], 0
  buffer_load_dwordx4 v[216:219], v2, s[36:39], s67 offen offset:2048 sc1
  v_mfma_f32_32x32x16_bf16 v[128:143], v[24:27], v[220:223], v[128:143]
  ds_write_b128 v9, v[148:151] offset:1024
  v_mfma_f32_32x32x16_bf16 v[160:175], v[28:31], v[220:223], v[160:175]
  buffer_load_dwordx4 v[220:223], v2, s[36:39], s67 offen offset:3072 sc1
  v_mfma_f32_32x32x16_bf16 v[128:143], v[32:35], v[224:227], v[128:143]
  ds_write_b128 v9, v[152:155] offset:2048
  v_mfma_f32_32x32x16_bf16 v[160:175], v[36:39], v[224:227], v[160:175]
  s_add_u32 s67, s11, 4096
  buffer_load_dwordx4 v[224:227], v2, s[36:39], s67 offen offset:0 sc1
  v_mfma_f32_32x32x16_bf16 v[128:143], v[40:43], v[228:231], v[128:143]
  ds_write_b128 v9, v[156:159] offset:3072
  v_mfma_f32_32x32x16_bf16 v[160:175], v[44:47], v[228:231], v[160:175]
  buffer_load_dwordx4 v[228:231], v2, s[36:39], s67 offen offset:1024 sc1
  v_mfma_f32_32x32x16_bf16 v[128:143], v[48:51], v[232:235], v[128:143]
  ds_write_b128 v9, v[176:179] offset:4096
  v_mfma_f32_32x32x16_bf16 v[160:175], v[52:55], v[232:235], v[160:175]
  buffer_load_dwordx4 v[232:235], v2, s[36:39], s67 offen offset:2048 sc1
  v_mfma_f32_32x32x16_bf16 v[128:143], v[56:59], v[236:239], v[128:143]
  ds_write_b128 v9, v[180:183] offset:5120
  v_mfma_f32_32x32x16_bf16 v[160:175], v[60:63], v[236:239], v[160:175]
  s_waitcnt vmcnt(14)
  buffer_load_dwordx4 v[236:239], v2, s[36:39], s67 offen offset:3072 sc1
  v_mfma_f32_32x32x16_bf16 v[128:143], v[64:67], v[240:243], v[128:143]
  ds_write_b128 v9, v[184:187] offset:6144
  v_mfma_f32_32x32x16_bf16 v[160:175], v[68:71], v[240:243], v[160:175]
  s_waitcnt vmcnt(14)
  s_add_u32 s67, s11, 8192
  buffer_load_dwordx4 v[240:243], v2, s[36:39], s67 offen offset:0 sc1
  v_mfma_f32_32x32x16_bf16 v[128:143], v[72:75], v[244:247], v[128:143]
  ds_write_b128 v9, v[188:191] offset:7168
  v_mfma_f32_32x32x16_bf16 v[160:175], v[76:79], v[244:247], v[160:175]
  s_waitcnt vmcnt(14)
  buffer_load_dwordx4 v[244:247], v2, s[36:39], s67 offen offset:1024 sc1
  v_mfma_f32_32x32x16_bf16 v[128:143], v[80:83], v[248:251], v[128:143]
  s_waitcnt lgkmcnt(0)
  s_mov_b64 exec, 1
  ds_add_u32 v3, v1 offset:0
  s_mov_b64 exec, -1
  v_mfma_f32_32x32x16_bf16 v[160:175], v[84:87], v[248:251], v[160:175]
  s_waitcnt vmcnt(14)
  buffer_load_dwordx4 v[248:251], v2, s[36:39], s67 offen offset:2048 sc1
  v_mfma_f32_32x32x16_bf16 v[128:143], v[88:91], v[252:255], v[128:143]
  ds_read_b32 v4, v3 offset:0
  v_mfma_f32_32x32x16_bf16 v[160:175], v[92:95], v[252:255], v[160:175]
  s_waitcnt vmcnt(14)
  buffer_load_dwordx4 v[252:255], v2, s[36:39], s67 offen offset:3072 sc1
  v_mfma_f32_32x32x16_bf16 v[128:143], v[96:99], v[192:195], v[128:143]
  s_waitcnt lgkmcnt(0)
  v_readfirstlane_b32 s3, v4
  s_nop 0
  s_cmp_lt_u32 s3, 1040
  s_cbranch_scc0 EL_f5191
  v_mov_b32 v3, 155648
  s_mov_b32 s66, 1048576
LP_f5193:
  ds_read_b32 v4, v3 offset:0
  s_sub_u32 s66, s66, 1
  s_waitcnt lgkmcnt(0)
  v_readfirstlane_b32 s3, v4
  s_nop 0
  s_cmp_lt_u32 s3, 1040
  s_cselect_b32 s3, s66, 0
  s_cmp_lg_u32 s3, 0
  s_cbranch_scc1 LP_f5193
EL_f5191:
  ds_read_b128 v[144:147], v11 offset:0
  ds_read_b128 v[148:151], v11 offset:1024
  v_mfma_f32_32x32x16_bf16 v[160:175], v[100:103], v[192:195], v[160:175]
  s_waitcnt vmcnt(14)
  s_add_u32 s67, s11, 12288
  buffer_load_dwordx4 v[192:195], v2, s[36:39], s67 offen offset:0 sc1
  ds_read_b128 v[152:155], v11 offset:2048
  ds_read_b128 v[156:159], v11 offset:3072
  v_mfma_f32_32x32x16_bf16 v[128:143], v[104:107], v[196:199], v[128:143]
  ds_read_b128 v[176:179], v11 offset:4096
  ds_read_b128 v[180:183], v11 offset:5120
  v_mfma_f32_32x32x16_bf16 v[160:175], v[108:111], v[196:199], v[160:175]
  s_waitcnt vmcnt(14)
  buffer_load_dwordx4 v[196:199], v2, s[36:39], s67 offen offset:1024 sc1
  ds_read_b128 v[184:187], v11 offset:6144
  ds_read_b128 v[188:191], v11 offset:7168
  v_mfma_f32_32x32x16_bf16 v[128:143], v[112:115], v[200:203], v[128:143]
  v_mfma_f32_32x32x16_bf16 v[160:175], v[116:119], v[200:203], v[160:175]
  s_waitcnt vmcnt(14)
  s_add_u32 s67, s12, 0
  buffer_load_dwordx4 v[200:203], v2, s[36:39], s67 offen offset:0 sc1
  v_mfma_f32_32x32x16_bf16 v[128:143], v[120:123], v[204:207], v[128:143]
  s_waitcnt lgkmcnt(0)
  s_mov_b64 exec, 1
  ds_add_u32 v3, v1 offset:0
  s_mov_b64 exec, -1
  v_mfma_f32_32x32x16_bf16 v[160:175], v[124:127], v[204:207], v[160:175]
  s_waitcnt vmcnt(14)
  buffer_load_dwordx4 v[204:207], v2, s[36:39], s67 offen offset:1024 sc1
  v_mfma_f32_32x32x16_bf16 v[144:159], v[16:19], v[208:211], v[144:159]
  s_nop 3
  ds_write_b128 v9, v[128:131] offset:8192
  v_mfma_f32_32x32x16_bf16 v[176:191], v[20:23], v[208:211], v[176:191]
  s_waitcnt vmcnt(14)
  buffer_load_dwordx4 v[208:211], v2, s[36:39], s67 offen offset:2048 sc1
  v_mfma_f32_32x32x16_bf16 v[144:159], v[24:27], v[212:215], v[144:159]
  ds_write_b128 v9, v[132:135] offset:9216
  v_mfma_f32_32x32x16_bf16 v[176:191], v[28:31], v[212:215], v[176:191]
  s_waitcnt vmcnt(14)
  buffer_load_dwordx4 v[212:215], v2, s[36:39], s67 offen offset:3072 sc1
  v_mfma_f32_32x32x16_bf16 v[144:159], v[32:35], v[216:219], v[144:159]
  ds_write_b128 v9, v[136:139] offset:10240
  v_mfma_f32_32x32x16_bf16 v[176:191], v[36:39], v[216:219], v[176:191]
  s_waitcnt vmcnt(14)
  s_add_u32 s67, s12, 4096
  buffer_load_dwordx4 v[216:219], v2, s[36:39], s67 offen offset:0 sc1
  ds_read_b32 v4, v3 offset:0
  v_mfma_f32_32x32x16_bf16 v[144:159], v[40:43], v[220:223], v[144:159]
  ds_write_b128 v9, v[140:143] offset:11264
  v_mfma_f32_32x32x16_bf16 v[176:191], v[44:47], v[220:223], v[176:191]
  s_waitcnt vmcnt(14)
  buffer_load_dwordx4 v[220:223], v2, s[36:39], s67 offen offset:1024 sc1
  s_waitcnt lgkmcnt(1)
  v_readfirstlane_b32 s3, v4
  s_nop 0
  s_cmp_lt_u32 s3, 1044
  s_cbranch_scc0 EL_f5194
  v_mov_b32 v3, 155648
  s_mov_b32 s66, 1048576
LP_f5196:
  ds_read_b32 v4, v3 offset:0
  s_sub_u32 s66, s66, 1
  s_waitcnt lgkmcnt(0)
  v_readfirstlane_b32 s3, v4
  s_nop 0
  s_cmp_lt_u32 s3, 1044
  s_cselect_b32 s3, s66, 0
  s_cmp_lg_u32 s3, 0
  s_cbranch_scc1 LP_f5196
EL_f5194:
  v_mfma_f32_32x32x16_bf16 v[144:159], v[48:51], v[224:227], v[144:159]
  ds_write_b128 v9, v[160:163] offset:0
  v_mfma_f32_32x32x16_bf16 v[176:191], v[52:55], v[224:227], v[176:191]
  s_waitcnt vmcnt(14)
  buffer_load_dwordx4 v[224:227], v2, s[36:39], s67 offen offset:2048 sc1
  v_mfma_f32_32x32x16_bf16 v[144:159], v[56:59], v[228:231], v[144:159]
  ds_write_b128 v9, v[164:167] offset:1024
  v_mfma_f32_32x32x16_bf16 v[176:191], v[60:63], v[228:231], v[176:191]
  s_waitcnt vmcnt(14)
  buffer_load_dwordx4 v[228:231], v2, s[36:39], s67 offen offset:3072 sc1
  v_mfma_f32_32x32x16_bf16 v[144:159], v[64:67], v[232:235], v[144:159]
  ds_write_b128 v9, v[168:171] offset:2048
  v_mfma_f32_32x32x16_bf16 v[176:191], v[68:71], v[232:235], v[176:191]
  s_waitcnt vmcnt(14)
  s_add_u32 s67, s12, 8192
  buffer_load_dwordx4 v[232:235], v2, s[36:39], s67 offen offset:0 sc1
  v_mfma_f32_32x32x16_bf16 v[144:159], v[72:75], v[236:239], v[144:159]
  ds_write_b128 v9, v[172:175] offset:3072
  v_mfma_f32_32x32x16_bf16 v[176:191], v[76:79], v[236:239], v[176:191]
  s_waitcnt vmcnt(14)
  buffer_load_dwordx4 v[236:239], v2, s[36:39], s67 offen offset:1024 sc1
  v_mfma_f32_32x32x16_bf16 v[176:191], v[84:87], v[240:243], v[176:191]
  s_waitcnt vmcnt(14)
  s_waitcnt lgkmcnt(0)
  s_mov_b64 exec, 1
  ds_add_u32 v3, v1 offset:0
  s_mov_b64 exec, -1
  v_mfma_f32_32x32x16_bf16 v[176:191], v[92:95], v[244:247], v[176:191]
  s_waitcnt vmcnt(13)
  ds_read_b32 v4, v3 offset:0
  v_mfma_f32_32x32x16_bf16 v[176:191], v[100:103], v[248:251], v[176:191]
  s_waitcnt vmcnt(12)
  v_mfma_f32_32x32x16_bf16 v[176:191], v[108:111], v[252:255], v[176:191]
  s_waitcnt vmcnt(11)
  s_waitcnt lgkmcnt(0)
  v_readfirstlane_b32 s3, v4
  s_nop 0
  s_cmp_lt_u32 s3, 1048
  s_cbranch_scc0 EL_f5197
  v_mov_b32 v3, 155648
  s_mov_b32 s66, 1048576
LP_f5199:
  ds_read_b32 v4, v3 offset:0
  s_sub_u32 s66, s66, 1
  s_waitcnt lgkmcnt(0)
  v_readfirstlane_b32 s3, v4
  s_nop 0
  s_cmp_lt_u32 s3, 1048
  s_cselect_b32 s3, s66, 0
  s_cmp_lg_u32 s3, 0
  s_cbranch_scc1 LP_f5199
EL_f5197:
  ds_read_b128 v[160:163], v11 offset:0
  ds_read_b128 v[164:167], v11 offset:1024
  v_mfma_f32_32x32x16_bf16 v[176:191], v[116:119], v[192:195], v[176:191]
  s_waitcnt vmcnt(10)
  ds_read_b128 v[168:171], v11 offset:2048
  ds_read_b128 v[172:175], v11 offset:3072
  v_mfma_f32_32x32x16_bf16 v[176:191], v[124:127], v[196:199], v[176:191]
  ds_read_b128 v[128:131], v11 offset:8192
  ds_read_b128 v[132:135], v11 offset:9216
  v_mfma_f32_32x32x16_bf16 v[144:159], v[80:83], v[240:243], v[144:159]
  buffer_load_dwordx4 v[240:243], v2, s[36:39], s67 offen offset:2048 sc1
  ds_read_b128 v[136:139], v11 offset:10240
  ds_read_b128 v[140:143], v11 offset:11264
  v_mfma_f32_32x32x16_bf16 v[144:159], v[88:91], v[244:247], v[144:159]
  buffer_load_dwordx4 v[244:247], v2, s[36:39], s67 offen offset:3072 sc1
  s_nop 3
  ds_write_b128 v0, v[176:179] offset:4096
  v_mfma_f32_32x32x16_bf16 v[144:159], v[96:99], v[248:251], v[144:159]
  s_add_u32 s67, s12, 12288
  buffer_load_dwordx4 v[248:251], v2, s[36:39], s67 offen offset:0 sc1
  v_mfma_f32_32x32x16_bf16 v[144:159], v[104:107], v[252:255], v[144:159]
  buffer_load_dwordx4 v[252:255], v2, s[36:39], s67 offen offset:1024 sc1
  ds_write_b128 v0, v[180:183] offset:5120
  v_mfma_f32_32x32x16_bf16 v[144:159], v[112:115], v[192:195], v[144:159]
  v_mfma_f32_32x32x16_bf16 v[144:159], v[120:123], v[196:199], v[144:159]
  s_waitcnt vmcnt(13)
  ds_write_b128 v0, v[184:187] offset:6144
  s_waitcnt lgkmcnt(7)
  v_mfma_f32_32x32x16_bf16 v[160:175], v[20:23], v[200:203], v[160:175]
  s_waitcnt lgkmcnt(3)
  v_mfma_f32_32x32x16_bf16 v[128:143], v[16:19], v[200:203], v[128:143]
  s_waitcnt vmcnt(12)
  ds_write_b128 v0, v[188:191] offset:7168
  v_mfma_f32_32x32x16_bf16 v[160:175], v[28:31], v[204:207], v[160:175]
  v_mfma_f32_32x32x16_bf16 v[128:143], v[24:27], v[204:207], v[128:143]
  s_waitcnt vmcnt(11)
  s_waitcnt lgkmcnt(0)
  s_mov_b64 exec, 1
  ds_add_u32 v3, v1 offset:0
  s_mov_b64 exec, -1
  v_mfma_f32_32x32x16_bf16 v[160:175], v[36:39], v[208:211], v[160:175]
  ds_read_b32 v4, v3 offset:0
  v_mfma_f32_32x32x16_bf16 v[128:143], v[32:35], v[208:211], v[128:143]
  s_waitcnt vmcnt(10)
  v_mfma_f32_32x32x16_bf16 v[160:175], v[44:47], v[212:215], v[160:175]
  s_waitcnt lgkmcnt(0)
  v_readfirstlane_b32 s3, v4
  s_nop 0
  s_cmp_lt_u32 s3, 1052
  s_cbranch_scc0 EL_f5200
  v_mov_b32 v3, 155648
  s_mov_b32 s66, 1048576
LP_f5202:
  ds_read_b32 v4, v3 offset:0
  s_sub_u32 s66, s66, 1
  s_waitcnt lgkmcnt(0)
  v_readfirstlane_b32 s3, v4
  s_nop 0
  s_cmp_lt_u32 s3, 1052
  s_cselect_b32 s3, s66, 0
  s_cmp_lg_u32 s3, 0
  s_cbranch_scc1 LP_f5202
EL_f5200:
  ds_read_b128 v[176:179], v11 offset:4096
  ds_read_b128 v[180:183], v11 offset:5120
  v_mfma_f32_32x32x16_bf16 v[128:143], v[40:43], v[212:215], v[128:143]
  s_waitcnt vmcnt(9)
  ds_read_b128 v[184:187], v11 offset:6144
  ds_read_b128 v[188:191], v11 offset:7168
  v_mfma_f32_32x32x16_bf16 v[160:175], v[52:55], v[216:219], v[160:175]
  s_mov_b64 exec, 1
  ds_add_u32 v3, v5 offset:20
  s_mov_b64 exec, -1
  v_mfma_f32_32x32x16_bf16 v[128:143], v[48:51], v[216:219], v[128:143]
  s_waitcnt vmcnt(8)
  s_waitcnt lgkmcnt(4)
  v_add_f32 v144, v144, v176
  v_add_f32 v145, v145, v177
  v_add_f32 v146, v146, v178
  v_add_f32 v147, v147, v179
  v_perm_b32 v144, v144, v12, s14
  v_perm_b32 v145, v145, v12, s18
  buffer_store_dwordx4 v[144:147], v2, s[36:39], s13 offen offset:0 sc1
  v_mfma_f32_32x32x16_bf16 v[160:175], v[60:63], v[220:223], v[160:175]
  s_waitcnt lgkmcnt(3)
  v_add_f32 v148, v148, v180
  v_add_f32 v149, v149, v181
  v_add_f32 v150, v150, v182
  v_add_f32 v151, v151, v183
  v_perm_b32 v148, v148, v12, s14
  v_perm_b32 v149, v149, v12, s18
  buffer_store_dwordx4 v[148:151], v2, s[36:39], s13 offen offset:1024 sc1
  v_mfma_f32_32x32x16_bf16 v[128:143], v[56:59], v[220:223], v[128:143]
  s_waitcnt vmcnt(9)
  s_waitcnt lgkmcnt(2)
  v_add_f32 v152, v152, v184
  v_add_f32 v153, v153, v185
  v_add_f32 v154, v154, v186
  v_add_f32 v155, v155, v187
  v_perm_b32 v152, v152, v12, s14
  v_perm_b32 v153, v153, v12, s18
  buffer_store_dwordx4 v[152:155], v2, s[36:39], s13 offen offset:2048 sc1
  v_mfma_f32_32x32x16_bf16 v[160:175], v[68:71], v[224:227], v[160:175]
  s_waitcnt lgkmcnt(1)
  v_add_f32 v156, v156, v188
  v_add_f32 v157, v157, v189
  v_add_f32 v158, v158, v190
  v_add_f32 v159, v159, v191
  v_perm_b32 v156, v156, v12, s14
  v_perm_b32 v157, v157, v12, s18
  buffer_store_dwordx4 v[156:159], v2, s[36:39], s13 offen offset:3072 sc1
  v_mfma_f32_32x32x16_bf16 v[128:143], v[64:67], v[224:227], v[128:143]
  s_waitcnt vmcnt(10)
  v_mfma_f32_32x32x16_bf16 v[160:175], v[76:79], v[228:231], v[160:175]
  v_mfma_f32_32x32x16_bf16 v[128:143], v[72:75], v[228:231], v[128:143]
  s_waitcnt vmcnt(9)
  v_mfma_f32_32x32x16_bf16 v[160:175], v[84:87], v[232:235], v[160:175]
  s_waitcnt vmcnt(8)
  v_mfma_f32_32x32x16_bf16 v[160:175], v[92:95], v[236:239], v[160:175]
  s_waitcnt vmcnt(7)
  v_mfma_f32_32x32x16_bf16 v[160:175], v[100:103], v[240:243], v[160:175]
  s_waitcnt vmcnt(6)
  v_mfma_f32_32x32x16_bf16 v[160:175], v[108:111], v[244:247], v[160:175]
  s_waitcnt vmcnt(5)
  v_mfma_f32_32x32x16_bf16 v[160:175], v[116:119], v[248:251], v[160:175]
  s_waitcnt vmcnt(4)
  v_mfma_f32_32x32x16_bf16 v[160:175], v[124:127], v[252:255], v[160:175]
  v_mfma_f32_32x32x16_bf16 v[128:143], v[80:83], v[232:235], v[128:143]
  v_mfma_f32_32x32x16_bf16 v[128:143], v[88:91], v[236:239], v[128:143]
  s_nop 9
  ds_write_b128 v0, v[160:163] offset:8192
  v_mfma_f32_32x32x16_bf16 v[128:143], v[96:99], v[240:243], v[128:143]
  ds_write_b128 v0, v[164:167] offset:9216
  v_mfma_f32_32x32x16_bf16 v[128:143], v[104:107], v[244:247], v[128:143]
  ds_write_b128 v0, v[168:171] offset:10240
  v_mfma_f32_32x32x16_bf16 v[128:143], v[112:115], v[248:251], v[128:143]
  ds_write_b128 v0, v[172:175] offset:11264
  v_mfma_f32_32x32x16_bf16 v[128:143], v[120:123], v[252:255], v[128:143]
  s_nop 11
  ds_write_b128 v11, v[128:131] offset:0
  ds_write_b128 v11, v[132:135] offset:1024
  ds_write_b128 v11, v[136:139] offset:2048
  ds_write_b128 v11, v[140:143] offset:3072
  s_waitcnt lgkmcnt(0)
  s_mov_b64 exec, 1
  ds_add_u32 v3, v1 offset:0
  s_mov_b64 exec, -1
  s_barrier
  s_endpgm
EN_f5109:
.section .rodata,"a"
.p2align 6
.amdhsa_kernel gated_mix__softmax_full_mha__dense_activation_mish__prompt_kernel
  .amdhsa_next_free_vgpr 256
  .amdhsa_next_free_sgpr 102
  .amdhsa_accum_offset 256
  .amdhsa_group_segment_fixed_size 0
  .amdhsa_kernarg_size 88
  .amdhsa_user_sgpr_count 2
  .amdhsa_user_sgpr_kernarg_segment_ptr 1
  .amdhsa_system_sgpr_workgroup_id_x 1
.end_amdhsa_kernel
```
